```python
import torch

def _softmax(x, axis=-1):
    return torch.softmax(x, dim=axis)
def _gelu(x):
    return torch.nn.functional.gelu(x, approximate="tanh")
def _silu(x):
    return torch.nn.functional.silu(x)
def _sigmoid(x):
    return torch.sigmoid(x)
def _layernorm(x, axis=-1, eps=1e-5):
    m = x.mean(dim=axis, keepdim=True)
    v = x.var(dim=axis, keepdim=True, unbiased=False)
    return (x - m) / torch.sqrt(v + eps)
def _scatter_add(tgt, idx, src, axis=0):
    return tgt.clone().index_add_(axis, idx, src)
def _segment_sum(src, seg, n):
    out = torch.zeros((n,) + src.shape[1:], dtype=src.dtype)
    return out.index_add_(0, seg, src)
def _pad(x, pw):
    flat = tuple(v for pair in reversed(pw) for v in pair)
    return torch.nn.functional.pad(x, flat)

kernel_name = 'sequential_preLN__ssm_conv_h3__mixer_channel_mlp__prompt'

def setup_inputs():

    _w = (lambda a: (lambda t: t.to(torch.bfloat16) if t.is_floating_point() else t)(torch.as_tensor(a)))
    def _A_setup():
        B, S, D = 1, 2048, 1024
        ks = 4
        return {
            "q": _w((lambda *s: torch.randn(*s, dtype=torch.bfloat16) * 0.05)(B, S, D)),
            "k": _w((lambda *s: torch.randn(*s, dtype=torch.bfloat16) * 0.2)(B, S, D)),
            "v": _w((lambda *s: torch.randn(*s, dtype=torch.bfloat16) * 0.2)(B, S, D)),
            "shift_k": _w((lambda *s: torch.randn(*s, dtype=torch.bfloat16) * 0.2)(D, ks) * 0.5),
            "ssm_k": _w((lambda *s: torch.randn(*s, dtype=torch.bfloat16) * 0.8)(D, S) * (1.0 / S ** 0.5)),
            "ssm_D": _w((lambda *s: torch.randn(*s, dtype=torch.bfloat16) * 0.2)(D)),
        }
    _A_in = _A_setup()

    def _B_setup():
        B, S, D, F = 1, 2048, 1024, 3584
        return {
            "x": _w((lambda *s: torch.randn(*s, dtype=torch.bfloat16) * 0.05)(B, S, D)),
            "w1": _w((lambda *s: torch.randn(*s, dtype=torch.bfloat16) * 0.8)(D, F) * (D ** -0.5)),
            "b1": _w((lambda *s: torch.randn(*s, dtype=torch.bfloat16) * 0.4)(F)),
            "w2": _w((lambda *s: torch.randn(*s, dtype=torch.bfloat16) * 0.05)(F, D) * (F ** -0.5)),
            "b2": _w((lambda *s: torch.randn(*s, dtype=torch.bfloat16) * 0.05)(D)),
        }
    _B_in = _B_setup()

    return {
        "A_q": _A_in["q"],
        "A_k": _A_in["k"],
        "A_v": _A_in["v"],
        "A_shift_k": _A_in["shift_k"],
        "A_ssm_k": _A_in["ssm_k"],
        "A_ssm_D": _A_in["ssm_D"],
        "B_x": _B_in["x"],
        "B_w1": _B_in["w1"],
        "B_b1": _B_in["b1"],
        "B_w2": _B_in["w2"],
        "B_b2": _B_in["b2"],
    }

def reference(A_q, A_k, A_v, A_shift_k, A_ssm_k, A_ssm_D, B_x, B_w1, B_b1, B_w2, B_b2):
    def _A_ref(q, k, v, shift_k, ssm_k, ssm_D):
        B, S, D = q.shape
        ks = shift_k.shape[-1]
        k_pad = _pad(k, ((0, 0), (ks - 1, 0), (0, 0)))
        k_shift = torch.zeros_like(k)
        for t in range(ks):
            k_shift = k_shift + k_pad[:, t:t + S, :] * shift_k[:, ks - 1 - t][None, None, :]
        kv = k_shift * v
        L = 2 * S
        kv_pad = _pad(kv, ((0, 0), (0, S), (0, 0)))
        kf_pad = _pad(ssm_k, ((0, 0), (0, S)))
        kv_f = (lambda x, axes=(-2,-1): torch.fft.rfft2(x.float(), dim=axes))(kv_pad[:, None, :, :], axes=(1, 2))
        kf_f = (lambda x, axes=(-2,-1): torch.fft.rfft2(x.float(), dim=axes))(kf_pad[:, None, :], axes=(1, 2))
        kf_f = (lambda x, *d: x.permute(*d))(kf_f, 1, 2, 0)
        y_f = kv_f * kf_f[None, :, :, :]
        y = (lambda x, s, axes=(-2,-1): torch.fft.irfft2(x, s=s, dim=axes).to(torch.bfloat16))(y_f, (1, L), axes=(1, 2))[:, 0, :S, :]
        y = y + kv * ssm_D[None, None, :]
        return q * y

    def _B_ref(x, w1, b1, w2, b2):
        y = _layernorm(x, axis=-1)
        h = _gelu(torch.einsum("bsd,df->bsf", y, w1) + b1)
        return torch.einsum("bsf,fd->bsd", h, w2) + b2

    x = A_q
    h = x + _A_ref(_layernorm(x, axis=-1), A_k, A_v, A_shift_k, A_ssm_k, A_ssm_D)
    h2 = h + _B_ref(_layernorm(h, axis=-1), B_w1, B_b1, B_w2, B_b2)
    return h2
```

```asm
; @launch kernel=sequential_preLN__ssm_conv_h3__mixer_channel_mlp__prompt_kernel grid=(256,1,1) block=(512,1,1) lds=33024
; @launch kernel=k1_kernel grid=(256,1,1) block=(512,1,1) lds=51728
; @launch kernel=gz_kernel grid=(256,1,1) block=(512,1,1) lds=163840
.amdgcn_target "amdgcn-amd-amdhsa--gfx950"

.text
.globl sequential_preLN__ssm_conv_h3__mixer_channel_mlp__prompt_kernel
.p2align 8
.type sequential_preLN__ssm_conv_h3__mixer_channel_mlp__prompt_kernel,@function
sequential_preLN__ssm_conv_h3__mixer_channel_mlp__prompt_kernel:
s_cmp_ge_u32 s2, 256
s_cbranch_scc1 K0_END
s_load_dwordx4 s[4:7], s[0:1], 0
s_load_dwordx4 s[8:11], s[0:1], 16
s_load_dwordx2 s[12:13], s[0:1], 104
v_and_b32 v1, 63, v0
v_lshrrev_b32 v2, 6, v0
s_nop 0
v_readfirstlane_b32 s44, v2
s_nop 3
s_cmp_ge_u32 s44, 4
s_cbranch_scc1 K0_Q
CODE_K0_S:
s_and_b32 s48, s2, 7
s_lshr_b32 s49, s2, 3
s_lshl_b32 s50, s49, 17
s_lshl_b32 s51, s48, 8
s_add_u32 s50, s50, s51
v_and_b32 v84, 15, v0
v_lshrrev_b32 v85, 4, v0
v_lshlrev_b32 v86, 13, v85
v_lshl_add_u32 v86, v84, 4, v86
v_add_u32 v5, s50, v86
v_subrev_u32 v3, 6144, v5
v_subrev_u32 v4, 2048, v5
v_add_u32 v6, 4096, v5
s_lshl_b32 s51, s48, 10
v_lshl_add_u32 v7, v84, 6, s51
s_waitcnt lgkmcnt(0)
s_mov_b32 s20, s6
s_mov_b32 s21, s7
s_mov_b32 s22, 0x400000
s_mov_b32 s23, 0x20000
s_mov_b32 s24, s8
s_mov_b32 s25, s9
s_mov_b32 s26, 0x400000
s_mov_b32 s27, 0x20000
s_mov_b32 s28, s10
s_mov_b32 s29, s11
s_mov_b32 s30, 0x2000
s_mov_b32 s31, 0x20000
buffer_load_dwordx4 v[68:71], v7, s[28:31], 0 offen offset:0
buffer_load_dwordx4 v[72:75], v7, s[28:31], 0 offen offset:16
buffer_load_dwordx4 v[76:79], v7, s[28:31], 0 offen offset:32
buffer_load_dwordx4 v[80:83], v7, s[28:31], 0 offen offset:48
buffer_load_dwordx4 v[24:27], v3, s[20:23], 0 offen offset:0
buffer_load_dwordx4 v[28:31], v3, s[20:23], 0 offen offset:2048
buffer_load_dwordx4 v[32:35], v4, s[20:23], 0 offen offset:0
buffer_load_dwordx4 v[36:39], v5, s[20:23], 0 offen offset:0
buffer_load_dwordx4 v[40:43], v5, s[20:23], 0 offen offset:2048
buffer_load_dwordx4 v[44:47], v6, s[20:23], 0 offen offset:0
buffer_load_dwordx4 v[48:51], v6, s[20:23], 0 offen offset:2048
buffer_load_dwordx4 v[52:55], v5, s[24:27], 0 offen offset:0
buffer_load_dwordx4 v[56:59], v5, s[24:27], 0 offen offset:2048
buffer_load_dwordx4 v[60:63], v6, s[24:27], 0 offen offset:0
buffer_load_dwordx4 v[64:67], v6, s[24:27], 0 offen offset:2048
s_mov_b32 s32, s12
s_mov_b32 s33, s13
s_mov_b32 s34, 0x400000
s_mov_b32 s35, 0x20000
v_sub_u32 v4, 15, v85
v_and_b32 v5, 7, v84
v_lshlrev_b32 v5, 1, v5
v_xor_b32 v4, v4, v5
v_lshlrev_b32 v4, 3, v4
v_lshl_add_u32 v4, v84, 10, v4
v_add_u32 v4, 16640, v4
v_and_b32 v88, 7, v1
v_lshrrev_b32 v89, 3, v1
s_lshl_b32 s57, s44, 5
v_add_u32 v89, s57, v89
v_add_u32 v90, 0, v89
v_bfe_u32 v91, v90, 3, 3
v_xor_b32 v91, v91, v88
v_lshlrev_b32 v91, 4, v91
v_lshl_add_u32 v108, v90, 7, v91
v_add_u32 v90, 8, v89
v_bfe_u32 v91, v90, 3, 3
v_xor_b32 v91, v91, v88
v_lshlrev_b32 v91, 4, v91
v_lshl_add_u32 v109, v90, 7, v91
v_add_u32 v90, 16, v89
v_bfe_u32 v91, v90, 3, 3
v_xor_b32 v91, v91, v88
v_lshlrev_b32 v91, 4, v91
v_lshl_add_u32 v110, v90, 7, v91
v_add_u32 v90, 24, v89
v_bfe_u32 v91, v90, 3, 3
v_xor_b32 v91, v91, v88
v_lshlrev_b32 v91, 4, v91
v_lshl_add_u32 v111, v90, 7, v91
s_lshl_b32 s62, s48, 19
s_lshl_b32 s63, s49, 7
s_sub_u32 s63, 3968, s63
s_add_u32 s62, s62, s63
v_lshlrev_b32 v92, 12, v89
v_lshl_add_u32 v92, v88, 4, v92
v_add_u32 v92, s62, v92
s_mov_b32 s53, 0xffff0000
s_mov_b32 s60, 0x05040100
s_mov_b32 s61, 0x07060302
s_waitcnt vmcnt(4)
v_perm_b32 v112, v24, v28, s60
v_perm_b32 v126, v24, v28, s61
v_perm_b32 v113, v28, v32, s60
v_perm_b32 v127, v28, v32, s61
v_perm_b32 v114, v32, v36, s60
v_perm_b32 v128, v32, v36, s61
v_perm_b32 v115, v36, v40, s60
v_perm_b32 v129, v36, v40, s61
v_perm_b32 v116, v40, v44, s60
v_perm_b32 v130, v40, v44, s61
v_perm_b32 v117, v44, v48, s60
v_perm_b32 v131, v44, v48, s61
v_dot2_f32_bf16 v118, v112, v69, 0
v_dot2_f32_bf16 v132, v126, v71, 0
v_dot2_f32_bf16 v119, v113, v69, 0
v_dot2_f32_bf16 v133, v127, v71, 0
v_dot2_f32_bf16 v120, v114, v69, 0
v_dot2_f32_bf16 v134, v128, v71, 0
v_dot2_f32_bf16 v121, v115, v69, 0
v_dot2_f32_bf16 v135, v129, v71, 0
v_dot2_f32_bf16 v118, v114, v68, v118
v_dot2_f32_bf16 v132, v128, v70, v132
v_dot2_f32_bf16 v119, v115, v68, v119
v_dot2_f32_bf16 v133, v129, v70, v133
v_dot2_f32_bf16 v120, v116, v68, v120
v_dot2_f32_bf16 v134, v130, v70, v134
v_dot2_f32_bf16 v121, v117, v68, v121
v_dot2_f32_bf16 v135, v131, v70, v135
s_waitcnt vmcnt(0)
v_lshlrev_b32 v122, 16, v52
v_and_b32 v136, s53, v52
v_lshlrev_b32 v123, 16, v56
v_and_b32 v137, s53, v56
v_lshlrev_b32 v124, 16, v60
v_and_b32 v138, s53, v60
v_lshlrev_b32 v125, 16, v64
v_and_b32 v139, s53, v64
v_mul_f32 v118, v118, v122
v_mul_f32 v132, v132, v136
v_mul_f32 v119, v119, v123
v_mul_f32 v133, v133, v137
v_mul_f32 v120, v120, v124
v_mul_f32 v134, v134, v138
v_mul_f32 v121, v121, v125
v_mul_f32 v135, v135, v139
v_cvt_pk_bf16_f32 v100, v121, v120
v_cvt_pk_bf16_f32 v102, v135, v134
v_cvt_pk_bf16_f32 v101, v119, v118
v_cvt_pk_bf16_f32 v103, v133, v132
ds_write_b64 v4, v[100:101] offset:0
ds_write_b64 v4, v[102:103] offset:128
v_perm_b32 v112, v25, v29, s60
v_perm_b32 v126, v25, v29, s61
v_perm_b32 v113, v29, v33, s60
v_perm_b32 v127, v29, v33, s61
v_perm_b32 v114, v33, v37, s60
v_perm_b32 v128, v33, v37, s61
v_perm_b32 v115, v37, v41, s60
v_perm_b32 v129, v37, v41, s61
v_perm_b32 v116, v41, v45, s60
v_perm_b32 v130, v41, v45, s61
v_perm_b32 v117, v45, v49, s60
v_perm_b32 v131, v45, v49, s61
v_dot2_f32_bf16 v118, v112, v73, 0
v_dot2_f32_bf16 v132, v126, v75, 0
v_dot2_f32_bf16 v119, v113, v73, 0
v_dot2_f32_bf16 v133, v127, v75, 0
v_dot2_f32_bf16 v120, v114, v73, 0
v_dot2_f32_bf16 v134, v128, v75, 0
v_dot2_f32_bf16 v121, v115, v73, 0
v_dot2_f32_bf16 v135, v129, v75, 0
v_dot2_f32_bf16 v118, v114, v72, v118
v_dot2_f32_bf16 v132, v128, v74, v132
v_dot2_f32_bf16 v119, v115, v72, v119
v_dot2_f32_bf16 v133, v129, v74, v133
v_dot2_f32_bf16 v120, v116, v72, v120
v_dot2_f32_bf16 v134, v130, v74, v134
v_dot2_f32_bf16 v121, v117, v72, v121
v_dot2_f32_bf16 v135, v131, v74, v135
v_lshlrev_b32 v122, 16, v53
v_and_b32 v136, s53, v53
v_lshlrev_b32 v123, 16, v57
v_and_b32 v137, s53, v57
v_lshlrev_b32 v124, 16, v61
v_and_b32 v138, s53, v61
v_lshlrev_b32 v125, 16, v65
v_and_b32 v139, s53, v65
v_mul_f32 v118, v118, v122
v_mul_f32 v132, v132, v136
v_mul_f32 v119, v119, v123
v_mul_f32 v133, v133, v137
v_mul_f32 v120, v120, v124
v_mul_f32 v134, v134, v138
v_mul_f32 v121, v121, v125
v_mul_f32 v135, v135, v139
v_cvt_pk_bf16_f32 v104, v121, v120
v_cvt_pk_bf16_f32 v106, v135, v134
v_cvt_pk_bf16_f32 v105, v119, v118
v_cvt_pk_bf16_f32 v107, v133, v132
ds_write_b64 v4, v[104:105] offset:256
ds_write_b64 v4, v[106:107] offset:384
v_perm_b32 v112, v26, v30, s60
v_perm_b32 v126, v26, v30, s61
v_perm_b32 v113, v30, v34, s60
v_perm_b32 v127, v30, v34, s61
v_perm_b32 v114, v34, v38, s60
v_perm_b32 v128, v34, v38, s61
v_perm_b32 v115, v38, v42, s60
v_perm_b32 v129, v38, v42, s61
v_perm_b32 v116, v42, v46, s60
v_perm_b32 v130, v42, v46, s61
v_perm_b32 v117, v46, v50, s60
v_perm_b32 v131, v46, v50, s61
v_dot2_f32_bf16 v118, v112, v77, 0
v_dot2_f32_bf16 v132, v126, v79, 0
v_dot2_f32_bf16 v119, v113, v77, 0
v_dot2_f32_bf16 v133, v127, v79, 0
v_dot2_f32_bf16 v120, v114, v77, 0
v_dot2_f32_bf16 v134, v128, v79, 0
v_dot2_f32_bf16 v121, v115, v77, 0
v_dot2_f32_bf16 v135, v129, v79, 0
v_dot2_f32_bf16 v118, v114, v76, v118
v_dot2_f32_bf16 v132, v128, v78, v132
v_dot2_f32_bf16 v119, v115, v76, v119
v_dot2_f32_bf16 v133, v129, v78, v133
v_dot2_f32_bf16 v120, v116, v76, v120
v_dot2_f32_bf16 v134, v130, v78, v134
v_dot2_f32_bf16 v121, v117, v76, v121
v_dot2_f32_bf16 v135, v131, v78, v135
v_lshlrev_b32 v122, 16, v54
v_and_b32 v136, s53, v54
v_lshlrev_b32 v123, 16, v58
v_and_b32 v137, s53, v58
v_lshlrev_b32 v124, 16, v62
v_and_b32 v138, s53, v62
v_lshlrev_b32 v125, 16, v66
v_and_b32 v139, s53, v66
v_mul_f32 v118, v118, v122
v_mul_f32 v132, v132, v136
v_mul_f32 v119, v119, v123
v_mul_f32 v133, v133, v137
v_mul_f32 v120, v120, v124
v_mul_f32 v134, v134, v138
v_mul_f32 v121, v121, v125
v_mul_f32 v135, v135, v139
v_cvt_pk_bf16_f32 v100, v121, v120
v_cvt_pk_bf16_f32 v102, v135, v134
v_cvt_pk_bf16_f32 v101, v119, v118
v_cvt_pk_bf16_f32 v103, v133, v132
ds_write_b64 v4, v[100:101] offset:512
ds_write_b64 v4, v[102:103] offset:640
v_perm_b32 v112, v27, v31, s60
v_perm_b32 v126, v27, v31, s61
v_perm_b32 v113, v31, v35, s60
v_perm_b32 v127, v31, v35, s61
v_perm_b32 v114, v35, v39, s60
v_perm_b32 v128, v35, v39, s61
v_perm_b32 v115, v39, v43, s60
v_perm_b32 v129, v39, v43, s61
v_perm_b32 v116, v43, v47, s60
v_perm_b32 v130, v43, v47, s61
v_perm_b32 v117, v47, v51, s60
v_perm_b32 v131, v47, v51, s61
v_dot2_f32_bf16 v118, v112, v81, 0
v_dot2_f32_bf16 v132, v126, v83, 0
v_dot2_f32_bf16 v119, v113, v81, 0
v_dot2_f32_bf16 v133, v127, v83, 0
v_dot2_f32_bf16 v120, v114, v81, 0
v_dot2_f32_bf16 v134, v128, v83, 0
v_dot2_f32_bf16 v121, v115, v81, 0
v_dot2_f32_bf16 v135, v129, v83, 0
v_dot2_f32_bf16 v118, v114, v80, v118
v_dot2_f32_bf16 v132, v128, v82, v132
v_dot2_f32_bf16 v119, v115, v80, v119
v_dot2_f32_bf16 v133, v129, v82, v133
v_dot2_f32_bf16 v120, v116, v80, v120
v_dot2_f32_bf16 v134, v130, v82, v134
v_dot2_f32_bf16 v121, v117, v80, v121
v_dot2_f32_bf16 v135, v131, v82, v135
v_lshlrev_b32 v122, 16, v55
v_and_b32 v136, s53, v55
v_lshlrev_b32 v123, 16, v59
v_and_b32 v137, s53, v59
v_lshlrev_b32 v124, 16, v63
v_and_b32 v138, s53, v63
v_lshlrev_b32 v125, 16, v67
v_and_b32 v139, s53, v67
v_mul_f32 v118, v118, v122
v_mul_f32 v132, v132, v136
v_mul_f32 v119, v119, v123
v_mul_f32 v133, v133, v137
v_mul_f32 v120, v120, v124
v_mul_f32 v134, v134, v138
v_mul_f32 v121, v121, v125
v_mul_f32 v135, v135, v139
v_cvt_pk_bf16_f32 v104, v121, v120
v_cvt_pk_bf16_f32 v106, v135, v134
v_cvt_pk_bf16_f32 v105, v119, v118
v_cvt_pk_bf16_f32 v107, v133, v132
ds_write_b64 v4, v[104:105] offset:768
ds_write_b64 v4, v[106:107] offset:896
s_waitcnt lgkmcnt(0)
s_barrier
ds_read_b128 v[24:27], v108 offset:16640
ds_read_b128 v[28:31], v109 offset:16640
ds_read_b128 v[32:35], v110 offset:16640
ds_read_b128 v[36:39], v111 offset:16640
s_waitcnt lgkmcnt(3)
s_mov_b32 s56, 0
buffer_store_dwordx4 v[24:27], v92, s[32:35], s56 offen sc1
s_waitcnt lgkmcnt(2)
s_mov_b32 s56, 32768
buffer_store_dwordx4 v[28:31], v92, s[32:35], s56 offen sc1
s_waitcnt lgkmcnt(1)
s_mov_b32 s56, 65536
buffer_store_dwordx4 v[32:35], v92, s[32:35], s56 offen sc1
s_waitcnt lgkmcnt(0)
s_mov_b32 s56, 98304
buffer_store_dwordx4 v[36:39], v92, s[32:35], s56 offen sc1
s_endpgm
K0_Q:
s_sub_u32 s44, s44, 4
s_and_b32 s45, s2, 7
s_lshl_b32 s45, s45, 5
s_lshr_b32 s46, s2, 3
s_add_u32 s45, s45, s46
s_lshl_b32 s46, s45, 3
s_lshl_b32 s47, s44, 1
s_add_u32 s47, s47, s46
s_lshl_b32 s47, s47, 11
v_lshlrev_b32 v3, 4, v1
v_add_u32 v2, s47, v3
s_mul_i32 s52, s44, 4160
v_add_u32 v3, s52, v3
s_waitcnt lgkmcnt(0)
s_mov_b32 s16, s4
s_mov_b32 s17, s5
s_mov_b32 s18, 0x400000
s_mov_b32 s19, 0x20000
buffer_load_dwordx4 v[8:11], v2, s[16:19], 0 offen offset:0
buffer_load_dwordx4 v[12:15], v2, s[16:19], 0 offen offset:1024
buffer_load_dwordx4 v[16:19], v2, s[16:19], 0 offen offset:2048
buffer_load_dwordx4 v[20:23], v2, s[16:19], 0 offen offset:3072
s_add_u32 s36, s12, 0x1000000
s_addc_u32 s37, s13, 0
s_mov_b32 s38, 0x400000
s_mov_b32 s39, 0x20000
s_add_u32 s40, s12, 0x1400000
s_addc_u32 s41, s13, 0
s_mov_b32 s42, 0x4000
s_mov_b32 s43, 0x20000
s_add_u32 s64, s12, 0x1408000
s_addc_u32 s65, s13, 0
s_mov_b32 s66, 0x4000
s_mov_b32 s67, 0x20000
v_mov_b32 v60, -1
v_mov_b32 v61, -1
v_and_b32 v62, 7, v1
v_lshlrev_b32 v62, 3, v62
s_lshl_b32 s56, s45, 6
buffer_store_dwordx2 v[60:61], v62, s[64:67], s56 offen sc1
s_add_u32 s68, s12, 0x1480000
s_addc_u32 s69, s13, 0
s_mov_b32 s70, 0x20000
s_mov_b32 s71, 0x20000
v_mov_b32 v63, 0
v_and_b32 v64, 3, v1
v_lshlrev_b32 v64, 7, v64
s_lshl_b32 s56, s2, 9
buffer_store_dword v63, v64, s[68:71], s56 offen sc1
s_add_u32 s20, s12, 0x14a0000
s_addc_u32 s21, s13, 0
s_mov_b32 s22, 0x8000
s_mov_b32 s23, 0x20000
s_lshl_b32 s56, s2, 7
buffer_store_dword v63, v63, s[20:23], s56 offen sc1
s_cmp_lg_u32 s44, 0
s_cbranch_scc1 CPFSKIP_k1
s_getpc_b64 s[60:61]
CPF_k1:
s_add_u32 s60, s60, CODE_K1_S-CPF_k1
s_addc_u32 s61, s61, 0
s_lshr_b32 s62, s2, 3
s_mul_i32 s62, s62, 320
s_min_u32 s63, s62, CODE_K1_E-CODE_K1_S-4
s_load_dword s96, s[60:61], s63
s_add_u32 s62, s62, 64
s_min_u32 s63, s62, CODE_K1_E-CODE_K1_S-4
s_load_dword s97, s[60:61], s63
s_add_u32 s62, s62, 64
s_min_u32 s63, s62, CODE_K1_E-CODE_K1_S-4
s_load_dword s98, s[60:61], s63
s_add_u32 s62, s62, 64
s_min_u32 s63, s62, CODE_K1_E-CODE_K1_S-4
s_load_dword s99, s[60:61], s63
s_add_u32 s62, s62, 64
s_min_u32 s63, s62, CODE_K1_E-CODE_K1_S-4
s_load_dword s96, s[60:61], s63
s_add_u32 s62, s62, 64
CPFSKIP_k1:
s_mov_b32 s53, 0xffff0000
s_waitcnt vmcnt(3)
ds_write_b128 v3, v[8:11] offset:0
ds_write_b128 v3, v[12:15] offset:1024
ds_write_b128 v3, v[16:19] offset:2080
ds_write_b128 v3, v[20:23] offset:3104
v_lshlrev_b32 v24, 16, v8
v_and_b32 v25, s53, v8
v_lshlrev_b32 v26, 16, v9
v_and_b32 v27, s53, v9
v_lshlrev_b32 v28, 16, v10
v_and_b32 v29, s53, v10
v_lshlrev_b32 v30, 16, v11
v_and_b32 v31, s53, v11
v_lshlrev_b32 v32, 16, v12
v_and_b32 v33, s53, v12
v_lshlrev_b32 v34, 16, v13
v_and_b32 v35, s53, v13
v_lshlrev_b32 v36, 16, v14
v_and_b32 v37, s53, v14
v_lshlrev_b32 v38, 16, v15
v_and_b32 v39, s53, v15
v_lshlrev_b32 v40, 16, v16
v_and_b32 v41, s53, v16
v_lshlrev_b32 v42, 16, v17
v_and_b32 v43, s53, v17
v_lshlrev_b32 v44, 16, v18
v_and_b32 v45, s53, v18
v_lshlrev_b32 v46, 16, v19
v_and_b32 v47, s53, v19
v_lshlrev_b32 v48, 16, v20
v_and_b32 v49, s53, v20
v_lshlrev_b32 v50, 16, v21
v_and_b32 v51, s53, v21
v_lshlrev_b32 v52, 16, v22
v_and_b32 v53, s53, v22
v_lshlrev_b32 v54, 16, v23
v_and_b32 v55, s53, v23
v_add_f32 v70, v24, v25
v_add_f32 v72, v26, v27
v_add_f32 v71, v40, v41
v_add_f32 v73, v42, v43
v_add_f32 v70, v70, v28
v_add_f32 v72, v72, v29
v_add_f32 v71, v71, v44
v_add_f32 v73, v73, v45
v_add_f32 v70, v70, v30
v_add_f32 v72, v72, v31
v_add_f32 v71, v71, v46
v_add_f32 v73, v73, v47
v_add_f32 v70, v70, v32
v_add_f32 v72, v72, v33
v_add_f32 v71, v71, v48
v_add_f32 v73, v73, v49
v_add_f32 v70, v70, v34
v_add_f32 v72, v72, v35
v_add_f32 v71, v71, v50
v_add_f32 v73, v73, v51
v_add_f32 v70, v70, v36
v_add_f32 v72, v72, v37
v_add_f32 v71, v71, v52
v_add_f32 v73, v73, v53
v_add_f32 v70, v70, v38
v_add_f32 v72, v72, v39
v_add_f32 v71, v71, v54
v_add_f32 v73, v73, v55
v_add_f32 v70, v70, v72
v_add_f32 v71, v71, v73
s_nop 0
v_add_f32_dpp v70, v70, v70 quad_perm:[1,0,3,2] row_mask:0xf bank_mask:0xf
v_add_f32_dpp v71, v71, v71 quad_perm:[1,0,3,2] row_mask:0xf bank_mask:0xf
s_nop 0
v_add_f32_dpp v70, v70, v70 quad_perm:[2,3,0,1] row_mask:0xf bank_mask:0xf
v_add_f32_dpp v71, v71, v71 quad_perm:[2,3,0,1] row_mask:0xf bank_mask:0xf
s_nop 0
v_add_f32_dpp v70, v70, v70 row_half_mirror row_mask:0xf bank_mask:0xf
v_add_f32_dpp v71, v71, v71 row_half_mirror row_mask:0xf bank_mask:0xf
s_nop 0
v_add_f32_dpp v70, v70, v70 row_mirror row_mask:0xf bank_mask:0xf
v_add_f32_dpp v71, v71, v71 row_mirror row_mask:0xf bank_mask:0xf
v_mov_b32 v72, v70
v_mov_b32 v73, v71
s_nop 0
v_permlane16_swap_b32 v70, v72
v_permlane16_swap_b32 v71, v73
v_add_f32 v70, v70, v72
v_add_f32 v71, v71, v73
v_mov_b32 v72, v70
v_mov_b32 v73, v71
s_nop 0
v_permlane32_swap_b32 v70, v72
v_permlane32_swap_b32 v71, v73
v_add_f32 v70, v70, v72
v_add_f32 v71, v71, v73
s_mov_b32 s54, 0x3a800000
v_mul_f32 v70, s54, v70
v_mul_f32 v71, s54, v71
v_sub_f32 v24, v24, v70
v_sub_f32 v40, v40, v71
v_sub_f32 v25, v25, v70
v_sub_f32 v41, v41, v71
v_sub_f32 v26, v26, v70
v_sub_f32 v42, v42, v71
v_sub_f32 v27, v27, v70
v_sub_f32 v43, v43, v71
v_sub_f32 v28, v28, v70
v_sub_f32 v44, v44, v71
v_sub_f32 v29, v29, v70
v_sub_f32 v45, v45, v71
v_sub_f32 v30, v30, v70
v_sub_f32 v46, v46, v71
v_sub_f32 v31, v31, v70
v_sub_f32 v47, v47, v71
v_sub_f32 v32, v32, v70
v_sub_f32 v48, v48, v71
v_sub_f32 v33, v33, v70
v_sub_f32 v49, v49, v71
v_sub_f32 v34, v34, v70
v_sub_f32 v50, v50, v71
v_sub_f32 v35, v35, v70
v_sub_f32 v51, v51, v71
v_sub_f32 v36, v36, v70
v_sub_f32 v52, v52, v71
v_sub_f32 v37, v37, v70
v_sub_f32 v53, v53, v71
v_sub_f32 v38, v38, v70
v_sub_f32 v54, v54, v71
v_sub_f32 v39, v39, v70
v_sub_f32 v55, v55, v71
v_mul_f32 v74, v24, v24
v_mul_f32 v76, v25, v25
v_mul_f32 v75, v40, v40
v_mul_f32 v77, v41, v41
v_fmac_f32 v74, v26, v26
v_fmac_f32 v76, v27, v27
v_fmac_f32 v75, v42, v42
v_fmac_f32 v77, v43, v43
v_fmac_f32 v74, v28, v28
v_fmac_f32 v76, v29, v29
v_fmac_f32 v75, v44, v44
v_fmac_f32 v77, v45, v45
v_fmac_f32 v74, v30, v30
v_fmac_f32 v76, v31, v31
v_fmac_f32 v75, v46, v46
v_fmac_f32 v77, v47, v47
v_fmac_f32 v74, v32, v32
v_fmac_f32 v76, v33, v33
v_fmac_f32 v75, v48, v48
v_fmac_f32 v77, v49, v49
v_fmac_f32 v74, v34, v34
v_fmac_f32 v76, v35, v35
v_fmac_f32 v75, v50, v50
v_fmac_f32 v77, v51, v51
v_fmac_f32 v74, v36, v36
v_fmac_f32 v76, v37, v37
v_fmac_f32 v75, v52, v52
v_fmac_f32 v77, v53, v53
v_fmac_f32 v74, v38, v38
v_fmac_f32 v76, v39, v39
v_fmac_f32 v75, v54, v54
v_fmac_f32 v77, v55, v55
v_add_f32 v74, v74, v76
v_add_f32 v75, v75, v77
s_nop 0
v_add_f32_dpp v74, v74, v74 quad_perm:[1,0,3,2] row_mask:0xf bank_mask:0xf
v_add_f32_dpp v75, v75, v75 quad_perm:[1,0,3,2] row_mask:0xf bank_mask:0xf
s_nop 0
v_add_f32_dpp v74, v74, v74 quad_perm:[2,3,0,1] row_mask:0xf bank_mask:0xf
v_add_f32_dpp v75, v75, v75 quad_perm:[2,3,0,1] row_mask:0xf bank_mask:0xf
s_nop 0
v_add_f32_dpp v74, v74, v74 row_half_mirror row_mask:0xf bank_mask:0xf
v_add_f32_dpp v75, v75, v75 row_half_mirror row_mask:0xf bank_mask:0xf
s_nop 0
v_add_f32_dpp v74, v74, v74 row_mirror row_mask:0xf bank_mask:0xf
v_add_f32_dpp v75, v75, v75 row_mirror row_mask:0xf bank_mask:0xf
v_mov_b32 v72, v74
v_mov_b32 v73, v75
s_nop 0
v_permlane16_swap_b32 v74, v72
v_permlane16_swap_b32 v75, v73
v_add_f32 v74, v74, v72
v_add_f32 v75, v75, v73
v_mov_b32 v72, v74
v_mov_b32 v73, v75
s_nop 0
v_permlane32_swap_b32 v74, v72
v_permlane32_swap_b32 v75, v73
v_add_f32 v74, v74, v72
v_add_f32 v75, v75, v73
s_mov_b32 s55, 0x3727c5ac
v_mov_b32 v76, s55
v_fma_f32 v74, v74, s54, v76
v_fma_f32 v75, v75, s54, v76
v_rsq_f32 v74, v74
v_rsq_f32 v75, v75
v_mov_b32 v80, v74
v_mov_b32 v81, v75
v_mul_f32 v82, v70, v74
v_mul_f32 v83, v71, v75
v_sub_f32 v82, 0, v82
v_sub_f32 v83, 0, v83
s_lshr_b32 s56, s47, 8
v_mov_b32 v79, s56
s_mov_b64 s[58:59], exec
s_mov_b64 exec, 1
buffer_store_dwordx4 v[80:83], v79, s[40:43], 0 offen sc1
s_mov_b64 exec, s[58:59]
s_waitcnt lgkmcnt(0)
s_barrier
v_and_b32 v84, 3, v0
v_bfe_u32 v85, v0, 2, 6
v_mul_u32_u24 v86, 4160, v84
v_lshl_add_u32 v86, v85, 3, v86
ds_read_b64 v[8:9], v86 offset:0
ds_read_b64 v[10:11], v86 offset:2080
ds_read_b64 v[12:13], v86 offset:512
ds_read_b64 v[14:15], v86 offset:2592
ds_read_b64 v[16:17], v86 offset:1024
ds_read_b64 v[18:19], v86 offset:3104
ds_read_b64 v[20:21], v86 offset:1536
ds_read_b64 v[22:23], v86 offset:3616
v_lshlrev_b32 v87, 14, v85
v_lshl_add_u32 v87, v84, 4, v87
s_lshl_b32 s56, s45, 6
v_add_u32 v87, s56, v87
s_waitcnt lgkmcnt(6)
s_mov_b32 s56, 0
buffer_store_dwordx4 v[8:11], v87, s[36:39], s56 offen sc1
s_waitcnt lgkmcnt(4)
s_mov_b32 s56, 1048576
buffer_store_dwordx4 v[12:15], v87, s[36:39], s56 offen sc1
s_waitcnt lgkmcnt(2)
s_mov_b32 s56, 2097152
buffer_store_dwordx4 v[16:19], v87, s[36:39], s56 offen sc1
s_waitcnt lgkmcnt(0)
s_mov_b32 s56, 3145728
buffer_store_dwordx4 v[20:23], v87, s[36:39], s56 offen sc1
s_endpgm
CODE_K0_E:
K0_END:
s_endpgm

.text
.globl k1_kernel
.p2align 8
.type k1_kernel,@function
k1_kernel:
s_cmp_ge_u32 s2, 256
s_cbranch_scc1 K1_END
CODE_K1_S:
s_load_dwordx4 s[4:7], s[0:1], 32
s_load_dwordx2 s[8:9], s[0:1], 56
s_load_dwordx2 s[10:11], s[0:1], 72
s_load_dwordx2 s[12:13], s[0:1], 104
v_and_b32 v1, 63, v0
v_lshrrev_b32 v2, 6, v0
s_nop 0
v_readfirstlane_b32 s44, v2
s_nop 3
s_cmp_ge_u32 s44, 4
s_cbranch_scc1 K1_HELP
s_lshl_b32 s45, s2, 2
s_add_u32 s45, s45, s44
s_lshl_b32 s46, s45, 12
s_mul_i32 s47, s44, 12928
v_lshlrev_b32 v3, 4, v1
v_add_u32 v4, 2, v3
v_and_b32 v5, 15, v1
v_lshrrev_b32 v6, 4, v1
v_mov_b32 v12, 0
v_mov_b32 v13, 0
v_mov_b32 v14, 0
v_mov_b32 v15, 0
v_min_u32 v16, 6, v1
v_lshlrev_b32 v16, 2, v16
v_add_u32 v16, s47, v16
ds_write_b32 v16, v12
ds_write_b32 v16, v12 offset:4164
v_min_u32 v17, 29, v1
v_lshlrev_b32 v17, 4, v17
v_add_u32 v17, s47, v17
ds_write_b128 v17, v[12:15] offset:12416
v_mov_b32 v209, 51712
ds_write_b32 v209, v12
s_waitcnt lgkmcnt(0)
s_add_u32 s50, s4, s46
s_addc_u32 s51, s5, 0
s_load_dword s52, s[50:51], 0
s_lshl_b32 s48, s45, 1
s_and_b32 s48, s48, 0xfffffffc
s_add_u32 s50, s6, s48
s_addc_u32 s51, s7, 0
s_load_dword s53, s[50:51], 0
s_mov_b32 s16, s4
s_mov_b32 s17, s5
s_mov_b32 s18, 0x400000
s_mov_b32 s19, 0x20000
s_mov_b32 s20, s12
s_mov_b32 s21, s13
s_mov_b32 s22, 0x400000
s_mov_b32 s23, 0x20000
s_add_u32 m0, s47, 4192
s_add_u32 s48, s46, 0
buffer_load_dwordx4 v3, s[16:19], s48 offen lds
s_add_u32 m0, s47, 5216
s_add_u32 s48, s46, 1024
buffer_load_dwordx4 v3, s[16:19], s48 offen lds
s_add_u32 m0, s47, 6240
s_add_u32 s48, s46, 2048
buffer_load_dwordx4 v3, s[16:19], s48 offen lds
s_add_u32 m0, s47, 7264
s_add_u32 s48, s46, 3072
buffer_load_dwordx4 v3, s[16:19], s48 offen lds
s_add_u32 m0, s47, 32
s_add_u32 s48, s46, 0
buffer_load_dwordx4 v4, s[16:19], s48 offen lds
s_add_u32 m0, s47, 1056
s_add_u32 s48, s46, 1024
buffer_load_dwordx4 v4, s[16:19], s48 offen lds
s_add_u32 m0, s47, 2080
s_add_u32 s48, s46, 2048
buffer_load_dwordx4 v4, s[16:19], s48 offen lds
s_add_u32 m0, s47, 3104
s_add_u32 s48, s46, 3072
buffer_load_dwordx4 v4, s[16:19], s48 offen lds
s_add_u32 m0, s47, 8320
s_add_u32 s48, s46, 0
buffer_load_dwordx4 v3, s[20:23], s48 offen lds
s_add_u32 m0, s47, 9344
s_add_u32 s48, s46, 1024
buffer_load_dwordx4 v3, s[20:23], s48 offen lds
s_add_u32 m0, s47, 10368
s_add_u32 s48, s46, 2048
buffer_load_dwordx4 v3, s[20:23], s48 offen lds
s_add_u32 m0, s47, 11392
s_add_u32 s48, s46, 3072
buffer_load_dwordx4 v3, s[20:23], s48 offen lds
s_add_u32 s24, s12, 0x1000000
s_addc_u32 s25, s13, 0
s_mov_b32 s26, 0x400000
s_mov_b32 s27, 0x20000
s_add_u32 s28, s12, 0x1400000
s_addc_u32 s29, s13, 0
s_mov_b32 s30, 0x4000
s_mov_b32 s31, 0x20000
s_add_u32 s32, s12, 0x1000000
s_addc_u32 s33, s13, 0
s_mov_b32 s34, 0x400000
s_mov_b32 s35, 0x20000
s_lshl_b32 s48, s44, 12
v_add_u32 v7, s48, v3
s_lshl_b32 s49, s2, 14
buffer_load_dwordx4 v[176:179], v7, s[24:27], s49 offen offset:0
buffer_load_dwordx4 v[180:183], v7, s[24:27], s49 offen offset:1024
buffer_load_dwordx4 v[184:187], v7, s[24:27], s49 offen offset:2048
buffer_load_dwordx4 v[188:191], v7, s[24:27], s49 offen offset:3072
buffer_load_dwordx4 v[192:195], v7, s[28:31], 0 offen offset:0
buffer_load_dwordx4 v[196:199], v7, s[28:31], 0 offen offset:1024
buffer_load_dwordx4 v[200:203], v7, s[28:31], 0 offen offset:2048
buffer_load_dwordx4 v[204:207], v7, s[28:31], 0 offen offset:3072
s_barrier
v_and_b32 v18, 14, v5
v_lshlrev_b32 v18, 1, v18
v_lshl_add_u32 v18, v6, 4, v18
v_and_b32 v19, 1, v5
s_mov_b32 s59, 4164
v_mad_u32_u24 v18, v19, s59, v18
v_add_u32 v18, s47, v18
v_add_u32 v2, 0, v18
v_add_u32 v9, 1024, v18
v_add_u32 v10, 2048, v18
v_add_u32 v12, 3072, v18
v_sub_u32 v13, 15, v5
v_lshlrev_b32 v13, 5, v13
v_lshl_add_u32 v13, v6, 4, v13
v_add_u32 v13, s47, v13
v_add_u32 v13, 8320, v13
v_lshlrev_b32 v14, 5, v5
v_lshl_add_u32 v14, v6, 3, v14
v_sub_u32 v14, 8824, v14
v_add_u32 v14, s47, v14
v_lshl_add_u32 v15, v5, 2, v6
v_bfe_u32 v19, v15, 3, 2
v_xor_b32 v15, v15, v19
v_lshlrev_b32 v15, 4, v15
v_add_u32 v15, s47, v15
v_lshrrev_b32 v20, 1, v1
v_bfe_u32 v19, v20, 3, 2
v_xor_b32 v20, v20, v19
v_lshlrev_b32 v20, 4, v20
v_and_b32 v19, 1, v1
v_lshl_add_u32 v20, v19, 3, v20
s_lshl_b32 s63, s44, 11
v_add_u32 v208, s63, v20
s_waitcnt lgkmcnt(0)
s_lshl_b32 s52, s52, 16
v_mov_b32 v16, s52
v_mov_b32 v17, s47
ds_write_b32 v17, v16 offset:28
s_lshl_b32 s60, s53, 16
s_and_b32 s61, s53, 0xffff0000
s_bitcmp1_b32 s44, 0
s_cselect_b32 s60, s61, s60
s_mov_b32 s53, 0xffff0000
s_waitcnt vmcnt(8) lgkmcnt(0)
ds_read2_b32 v[48:49], v2 offset0:0 offset1:1
ds_read2_b32 v[50:51], v2 offset0:2 offset1:3
ds_read_b128 v[112:115], v13 offset:3584
ds_read_b128 v[116:119], v13 offset:3072
ds_read_b128 v[120:123], v13 offset:2560
ds_read_b128 v[124:127], v13 offset:2048
ds_read_b128 v[128:131], v13 offset:1536
ds_read_b128 v[132:135], v13 offset:1024
ds_read_b128 v[136:139], v13 offset:512
ds_read_b128 v[140:143], v13 offset:0
ds_read2_b32 v[52:53], v2 offset0:128 offset1:129
ds_read2_b32 v[54:55], v2 offset0:130 offset1:131
ds_read2_b32 v[56:57], v9 offset0:0 offset1:1
ds_read2_b32 v[58:59], v9 offset0:2 offset1:3
ds_read2_b32 v[60:61], v9 offset0:128 offset1:129
ds_read2_b32 v[62:63], v9 offset0:130 offset1:131
ds_read2_b32 v[64:65], v10 offset0:0 offset1:1
ds_read2_b32 v[66:67], v10 offset0:2 offset1:3
ds_read2_b32 v[68:69], v10 offset0:128 offset1:129
ds_read2_b32 v[70:71], v10 offset0:130 offset1:131
ds_read2_b32 v[72:73], v12 offset0:0 offset1:1
ds_read2_b32 v[74:75], v12 offset0:2 offset1:3
ds_read2_b32 v[76:77], v12 offset0:128 offset1:129
ds_read2_b32 v[78:79], v12 offset0:130 offset1:131
s_waitcnt lgkmcnt(0)
v_mfma_f32_16x16x32_bf16 v[16:19], v[48:51], v[112:115], 0
ds_read2_b32 v[80:81], v2 offset0:16 offset1:17
v_mfma_f32_16x16x32_bf16 v[20:23], v[48:51], v[116:119], 0
ds_read2_b32 v[82:83], v2 offset0:18 offset1:19
v_mfma_f32_16x16x32_bf16 v[24:27], v[48:51], v[120:123], 0
ds_read_b128 v[144:147], v13 offset:3648
v_mfma_f32_16x16x32_bf16 v[28:31], v[48:51], v[124:127], 0
ds_read_b128 v[148:151], v13 offset:3136
v_mfma_f32_16x16x32_bf16 v[32:35], v[48:51], v[128:131], 0
ds_read_b128 v[152:155], v13 offset:2624
v_mfma_f32_16x16x32_bf16 v[36:39], v[48:51], v[132:135], 0
ds_read_b128 v[156:159], v13 offset:2112
v_mfma_f32_16x16x32_bf16 v[40:43], v[48:51], v[136:139], 0
ds_read_b128 v[160:163], v13 offset:1600
v_mfma_f32_16x16x32_bf16 v[44:47], v[48:51], v[140:143], 0
ds_read_b128 v[164:167], v13 offset:1088
v_mfma_f32_16x16x32_bf16 v[20:23], v[52:55], v[112:115], v[20:23]
ds_read_b128 v[168:171], v13 offset:576
v_mfma_f32_16x16x32_bf16 v[24:27], v[52:55], v[116:119], v[24:27]
ds_read_b128 v[172:175], v13 offset:64
v_mfma_f32_16x16x32_bf16 v[28:31], v[52:55], v[120:123], v[28:31]
ds_read2_b32 v[84:85], v2 offset0:144 offset1:145
v_mfma_f32_16x16x32_bf16 v[32:35], v[52:55], v[124:127], v[32:35]
ds_read2_b32 v[86:87], v2 offset0:146 offset1:147
v_mfma_f32_16x16x32_bf16 v[36:39], v[52:55], v[128:131], v[36:39]
ds_read2_b32 v[88:89], v9 offset0:16 offset1:17
v_mfma_f32_16x16x32_bf16 v[40:43], v[52:55], v[132:135], v[40:43]
ds_read2_b32 v[90:91], v9 offset0:18 offset1:19
v_mfma_f32_16x16x32_bf16 v[44:47], v[52:55], v[136:139], v[44:47]
ds_read2_b32 v[92:93], v9 offset0:144 offset1:145
v_mfma_f32_16x16x32_bf16 v[24:27], v[56:59], v[112:115], v[24:27]
ds_read2_b32 v[94:95], v9 offset0:146 offset1:147
v_mfma_f32_16x16x32_bf16 v[28:31], v[56:59], v[116:119], v[28:31]
ds_read2_b32 v[96:97], v10 offset0:16 offset1:17
v_mfma_f32_16x16x32_bf16 v[32:35], v[56:59], v[120:123], v[32:35]
ds_read2_b32 v[98:99], v10 offset0:18 offset1:19
v_mfma_f32_16x16x32_bf16 v[36:39], v[56:59], v[124:127], v[36:39]
ds_read2_b32 v[100:101], v10 offset0:144 offset1:145
v_mfma_f32_16x16x32_bf16 v[40:43], v[56:59], v[128:131], v[40:43]
ds_read2_b32 v[102:103], v10 offset0:146 offset1:147
v_mfma_f32_16x16x32_bf16 v[44:47], v[56:59], v[132:135], v[44:47]
ds_read2_b32 v[104:105], v12 offset0:16 offset1:17
v_mfma_f32_16x16x32_bf16 v[28:31], v[60:63], v[112:115], v[28:31]
ds_read2_b32 v[106:107], v12 offset0:18 offset1:19
v_mfma_f32_16x16x32_bf16 v[32:35], v[60:63], v[116:119], v[32:35]
ds_read2_b32 v[108:109], v12 offset0:144 offset1:145
v_mfma_f32_16x16x32_bf16 v[36:39], v[60:63], v[120:123], v[36:39]
ds_read2_b32 v[110:111], v12 offset0:146 offset1:147
v_mfma_f32_16x16x32_bf16 v[40:43], v[60:63], v[124:127], v[40:43]
v_mfma_f32_16x16x32_bf16 v[44:47], v[60:63], v[128:131], v[44:47]
v_mfma_f32_16x16x32_bf16 v[32:35], v[64:67], v[112:115], v[32:35]
v_mfma_f32_16x16x32_bf16 v[36:39], v[64:67], v[116:119], v[36:39]
v_mfma_f32_16x16x32_bf16 v[40:43], v[64:67], v[120:123], v[40:43]
v_mfma_f32_16x16x32_bf16 v[44:47], v[64:67], v[124:127], v[44:47]
v_mfma_f32_16x16x32_bf16 v[36:39], v[68:71], v[112:115], v[36:39]
v_mfma_f32_16x16x32_bf16 v[40:43], v[68:71], v[116:119], v[40:43]
v_mfma_f32_16x16x32_bf16 v[44:47], v[68:71], v[120:123], v[44:47]
v_mfma_f32_16x16x32_bf16 v[40:43], v[72:75], v[112:115], v[40:43]
v_mfma_f32_16x16x32_bf16 v[44:47], v[72:75], v[116:119], v[44:47]
v_mfma_f32_16x16x32_bf16 v[44:47], v[76:79], v[112:115], v[44:47]
s_waitcnt lgkmcnt(0)
v_mfma_f32_16x16x32_bf16 v[16:19], v[80:83], v[144:147], v[16:19]
ds_read2_b32 v[48:49], v2 offset0:32 offset1:33
v_mfma_f32_16x16x32_bf16 v[20:23], v[80:83], v[148:151], v[20:23]
ds_read2_b32 v[50:51], v2 offset0:34 offset1:35
v_mfma_f32_16x16x32_bf16 v[24:27], v[80:83], v[152:155], v[24:27]
ds_read_b128 v[112:115], v13 offset:3712
v_mfma_f32_16x16x32_bf16 v[28:31], v[80:83], v[156:159], v[28:31]
ds_read_b128 v[116:119], v13 offset:3200
v_mfma_f32_16x16x32_bf16 v[32:35], v[80:83], v[160:163], v[32:35]
ds_read_b128 v[120:123], v13 offset:2688
v_mfma_f32_16x16x32_bf16 v[36:39], v[80:83], v[164:167], v[36:39]
ds_read_b128 v[124:127], v13 offset:2176
v_mfma_f32_16x16x32_bf16 v[40:43], v[80:83], v[168:171], v[40:43]
ds_read_b128 v[128:131], v13 offset:1664
v_mfma_f32_16x16x32_bf16 v[44:47], v[80:83], v[172:175], v[44:47]
ds_read_b128 v[132:135], v13 offset:1152
v_mfma_f32_16x16x32_bf16 v[20:23], v[84:87], v[144:147], v[20:23]
ds_read_b128 v[136:139], v13 offset:640
v_mfma_f32_16x16x32_bf16 v[24:27], v[84:87], v[148:151], v[24:27]
ds_read_b128 v[140:143], v13 offset:128
v_mfma_f32_16x16x32_bf16 v[28:31], v[84:87], v[152:155], v[28:31]
ds_read2_b32 v[52:53], v2 offset0:160 offset1:161
v_mfma_f32_16x16x32_bf16 v[32:35], v[84:87], v[156:159], v[32:35]
ds_read2_b32 v[54:55], v2 offset0:162 offset1:163
v_mfma_f32_16x16x32_bf16 v[36:39], v[84:87], v[160:163], v[36:39]
ds_read2_b32 v[56:57], v9 offset0:32 offset1:33
v_mfma_f32_16x16x32_bf16 v[40:43], v[84:87], v[164:167], v[40:43]
ds_read2_b32 v[58:59], v9 offset0:34 offset1:35
v_mfma_f32_16x16x32_bf16 v[44:47], v[84:87], v[168:171], v[44:47]
ds_read2_b32 v[60:61], v9 offset0:160 offset1:161
v_mfma_f32_16x16x32_bf16 v[24:27], v[88:91], v[144:147], v[24:27]
ds_read2_b32 v[62:63], v9 offset0:162 offset1:163
v_mfma_f32_16x16x32_bf16 v[28:31], v[88:91], v[148:151], v[28:31]
ds_read2_b32 v[64:65], v10 offset0:32 offset1:33
v_mfma_f32_16x16x32_bf16 v[32:35], v[88:91], v[152:155], v[32:35]
ds_read2_b32 v[66:67], v10 offset0:34 offset1:35
v_mfma_f32_16x16x32_bf16 v[36:39], v[88:91], v[156:159], v[36:39]
ds_read2_b32 v[68:69], v10 offset0:160 offset1:161
v_mfma_f32_16x16x32_bf16 v[40:43], v[88:91], v[160:163], v[40:43]
ds_read2_b32 v[70:71], v10 offset0:162 offset1:163
v_mfma_f32_16x16x32_bf16 v[44:47], v[88:91], v[164:167], v[44:47]
ds_read2_b32 v[72:73], v12 offset0:32 offset1:33
v_mfma_f32_16x16x32_bf16 v[28:31], v[92:95], v[144:147], v[28:31]
ds_read2_b32 v[74:75], v12 offset0:34 offset1:35
v_mfma_f32_16x16x32_bf16 v[32:35], v[92:95], v[148:151], v[32:35]
ds_read2_b32 v[76:77], v12 offset0:160 offset1:161
v_mfma_f32_16x16x32_bf16 v[36:39], v[92:95], v[152:155], v[36:39]
ds_read2_b32 v[78:79], v12 offset0:162 offset1:163
v_mfma_f32_16x16x32_bf16 v[40:43], v[92:95], v[156:159], v[40:43]
v_mfma_f32_16x16x32_bf16 v[44:47], v[92:95], v[160:163], v[44:47]
v_mfma_f32_16x16x32_bf16 v[32:35], v[96:99], v[144:147], v[32:35]
v_mfma_f32_16x16x32_bf16 v[36:39], v[96:99], v[148:151], v[36:39]
v_mfma_f32_16x16x32_bf16 v[40:43], v[96:99], v[152:155], v[40:43]
v_mfma_f32_16x16x32_bf16 v[44:47], v[96:99], v[156:159], v[44:47]
v_mfma_f32_16x16x32_bf16 v[36:39], v[100:103], v[144:147], v[36:39]
v_mfma_f32_16x16x32_bf16 v[40:43], v[100:103], v[148:151], v[40:43]
v_mfma_f32_16x16x32_bf16 v[44:47], v[100:103], v[152:155], v[44:47]
v_mfma_f32_16x16x32_bf16 v[40:43], v[104:107], v[144:147], v[40:43]
v_mfma_f32_16x16x32_bf16 v[44:47], v[104:107], v[148:151], v[44:47]
v_mfma_f32_16x16x32_bf16 v[44:47], v[108:111], v[144:147], v[44:47]
s_waitcnt lgkmcnt(0)
v_mfma_f32_16x16x32_bf16 v[16:19], v[48:51], v[112:115], v[16:19]
ds_read2_b32 v[80:81], v2 offset0:48 offset1:49
v_mfma_f32_16x16x32_bf16 v[20:23], v[48:51], v[116:119], v[20:23]
ds_read2_b32 v[82:83], v2 offset0:50 offset1:51
v_mfma_f32_16x16x32_bf16 v[24:27], v[48:51], v[120:123], v[24:27]
ds_read_b128 v[144:147], v13 offset:3776
v_mfma_f32_16x16x32_bf16 v[28:31], v[48:51], v[124:127], v[28:31]
ds_read_b128 v[148:151], v13 offset:3264
v_mfma_f32_16x16x32_bf16 v[32:35], v[48:51], v[128:131], v[32:35]
ds_read_b128 v[152:155], v13 offset:2752
v_mfma_f32_16x16x32_bf16 v[36:39], v[48:51], v[132:135], v[36:39]
ds_read_b128 v[156:159], v13 offset:2240
v_mfma_f32_16x16x32_bf16 v[40:43], v[48:51], v[136:139], v[40:43]
ds_read_b128 v[160:163], v13 offset:1728
v_mfma_f32_16x16x32_bf16 v[44:47], v[48:51], v[140:143], v[44:47]
ds_read_b128 v[164:167], v13 offset:1216
v_mfma_f32_16x16x32_bf16 v[20:23], v[52:55], v[112:115], v[20:23]
ds_read_b128 v[168:171], v13 offset:704
v_mfma_f32_16x16x32_bf16 v[24:27], v[52:55], v[116:119], v[24:27]
ds_read_b128 v[172:175], v13 offset:192
v_mfma_f32_16x16x32_bf16 v[28:31], v[52:55], v[120:123], v[28:31]
ds_read2_b32 v[84:85], v2 offset0:176 offset1:177
v_mfma_f32_16x16x32_bf16 v[32:35], v[52:55], v[124:127], v[32:35]
ds_read2_b32 v[86:87], v2 offset0:178 offset1:179
v_mfma_f32_16x16x32_bf16 v[36:39], v[52:55], v[128:131], v[36:39]
ds_read2_b32 v[88:89], v9 offset0:48 offset1:49
v_mfma_f32_16x16x32_bf16 v[40:43], v[52:55], v[132:135], v[40:43]
ds_read2_b32 v[90:91], v9 offset0:50 offset1:51
v_mfma_f32_16x16x32_bf16 v[44:47], v[52:55], v[136:139], v[44:47]
ds_read2_b32 v[92:93], v9 offset0:176 offset1:177
v_mfma_f32_16x16x32_bf16 v[24:27], v[56:59], v[112:115], v[24:27]
ds_read2_b32 v[94:95], v9 offset0:178 offset1:179
v_mfma_f32_16x16x32_bf16 v[28:31], v[56:59], v[116:119], v[28:31]
ds_read2_b32 v[96:97], v10 offset0:48 offset1:49
v_mfma_f32_16x16x32_bf16 v[32:35], v[56:59], v[120:123], v[32:35]
ds_read2_b32 v[98:99], v10 offset0:50 offset1:51
v_mfma_f32_16x16x32_bf16 v[36:39], v[56:59], v[124:127], v[36:39]
ds_read2_b32 v[100:101], v10 offset0:176 offset1:177
v_mfma_f32_16x16x32_bf16 v[40:43], v[56:59], v[128:131], v[40:43]
ds_read2_b32 v[102:103], v10 offset0:178 offset1:179
v_mfma_f32_16x16x32_bf16 v[44:47], v[56:59], v[132:135], v[44:47]
ds_read2_b32 v[104:105], v12 offset0:48 offset1:49
v_mfma_f32_16x16x32_bf16 v[28:31], v[60:63], v[112:115], v[28:31]
ds_read2_b32 v[106:107], v12 offset0:50 offset1:51
v_mfma_f32_16x16x32_bf16 v[32:35], v[60:63], v[116:119], v[32:35]
ds_read2_b32 v[108:109], v12 offset0:176 offset1:177
v_mfma_f32_16x16x32_bf16 v[36:39], v[60:63], v[120:123], v[36:39]
ds_read2_b32 v[110:111], v12 offset0:178 offset1:179
v_mfma_f32_16x16x32_bf16 v[40:43], v[60:63], v[124:127], v[40:43]
v_mfma_f32_16x16x32_bf16 v[44:47], v[60:63], v[128:131], v[44:47]
v_mfma_f32_16x16x32_bf16 v[32:35], v[64:67], v[112:115], v[32:35]
v_mfma_f32_16x16x32_bf16 v[36:39], v[64:67], v[116:119], v[36:39]
v_mfma_f32_16x16x32_bf16 v[40:43], v[64:67], v[120:123], v[40:43]
v_mfma_f32_16x16x32_bf16 v[44:47], v[64:67], v[124:127], v[44:47]
v_mfma_f32_16x16x32_bf16 v[36:39], v[68:71], v[112:115], v[36:39]
v_mfma_f32_16x16x32_bf16 v[40:43], v[68:71], v[116:119], v[40:43]
v_mfma_f32_16x16x32_bf16 v[44:47], v[68:71], v[120:123], v[44:47]
v_mfma_f32_16x16x32_bf16 v[40:43], v[72:75], v[112:115], v[40:43]
v_mfma_f32_16x16x32_bf16 v[44:47], v[72:75], v[116:119], v[44:47]
v_mfma_f32_16x16x32_bf16 v[44:47], v[76:79], v[112:115], v[44:47]
s_waitcnt lgkmcnt(0)
v_mfma_f32_16x16x32_bf16 v[16:19], v[80:83], v[144:147], v[16:19]
ds_read2_b32 v[48:49], v2 offset0:64 offset1:65
v_mfma_f32_16x16x32_bf16 v[20:23], v[80:83], v[148:151], v[20:23]
ds_read2_b32 v[50:51], v2 offset0:66 offset1:67
v_mfma_f32_16x16x32_bf16 v[24:27], v[80:83], v[152:155], v[24:27]
ds_read_b128 v[112:115], v13 offset:3840
v_mfma_f32_16x16x32_bf16 v[28:31], v[80:83], v[156:159], v[28:31]
ds_read_b128 v[116:119], v13 offset:3328
v_mfma_f32_16x16x32_bf16 v[32:35], v[80:83], v[160:163], v[32:35]
ds_read_b128 v[120:123], v13 offset:2816
v_mfma_f32_16x16x32_bf16 v[36:39], v[80:83], v[164:167], v[36:39]
ds_read_b128 v[124:127], v13 offset:2304
v_mfma_f32_16x16x32_bf16 v[40:43], v[80:83], v[168:171], v[40:43]
ds_read_b128 v[128:131], v13 offset:1792
v_mfma_f32_16x16x32_bf16 v[44:47], v[80:83], v[172:175], v[44:47]
ds_read_b128 v[132:135], v13 offset:1280
v_mfma_f32_16x16x32_bf16 v[20:23], v[84:87], v[144:147], v[20:23]
ds_read_b128 v[136:139], v13 offset:768
v_mfma_f32_16x16x32_bf16 v[24:27], v[84:87], v[148:151], v[24:27]
ds_read_b128 v[140:143], v13 offset:256
v_mfma_f32_16x16x32_bf16 v[28:31], v[84:87], v[152:155], v[28:31]
ds_read2_b32 v[52:53], v2 offset0:192 offset1:193
v_mfma_f32_16x16x32_bf16 v[32:35], v[84:87], v[156:159], v[32:35]
ds_read2_b32 v[54:55], v2 offset0:194 offset1:195
v_mfma_f32_16x16x32_bf16 v[36:39], v[84:87], v[160:163], v[36:39]
ds_read2_b32 v[56:57], v9 offset0:64 offset1:65
v_mfma_f32_16x16x32_bf16 v[40:43], v[84:87], v[164:167], v[40:43]
ds_read2_b32 v[58:59], v9 offset0:66 offset1:67
v_mfma_f32_16x16x32_bf16 v[44:47], v[84:87], v[168:171], v[44:47]
ds_read2_b32 v[60:61], v9 offset0:192 offset1:193
v_mfma_f32_16x16x32_bf16 v[24:27], v[88:91], v[144:147], v[24:27]
ds_read2_b32 v[62:63], v9 offset0:194 offset1:195
v_mfma_f32_16x16x32_bf16 v[28:31], v[88:91], v[148:151], v[28:31]
ds_read2_b32 v[64:65], v10 offset0:64 offset1:65
v_mfma_f32_16x16x32_bf16 v[32:35], v[88:91], v[152:155], v[32:35]
ds_read2_b32 v[66:67], v10 offset0:66 offset1:67
v_mfma_f32_16x16x32_bf16 v[36:39], v[88:91], v[156:159], v[36:39]
ds_read2_b32 v[68:69], v10 offset0:192 offset1:193
v_mfma_f32_16x16x32_bf16 v[40:43], v[88:91], v[160:163], v[40:43]
ds_read2_b32 v[70:71], v10 offset0:194 offset1:195
v_mfma_f32_16x16x32_bf16 v[44:47], v[88:91], v[164:167], v[44:47]
ds_read2_b32 v[72:73], v12 offset0:64 offset1:65
v_mfma_f32_16x16x32_bf16 v[28:31], v[92:95], v[144:147], v[28:31]
ds_read2_b32 v[74:75], v12 offset0:66 offset1:67
v_mfma_f32_16x16x32_bf16 v[32:35], v[92:95], v[148:151], v[32:35]
ds_read2_b32 v[76:77], v12 offset0:192 offset1:193
v_mfma_f32_16x16x32_bf16 v[36:39], v[92:95], v[152:155], v[36:39]
ds_read2_b32 v[78:79], v12 offset0:194 offset1:195
v_mfma_f32_16x16x32_bf16 v[40:43], v[92:95], v[156:159], v[40:43]
v_mfma_f32_16x16x32_bf16 v[44:47], v[92:95], v[160:163], v[44:47]
v_mfma_f32_16x16x32_bf16 v[32:35], v[96:99], v[144:147], v[32:35]
v_mfma_f32_16x16x32_bf16 v[36:39], v[96:99], v[148:151], v[36:39]
v_mfma_f32_16x16x32_bf16 v[40:43], v[96:99], v[152:155], v[40:43]
v_mfma_f32_16x16x32_bf16 v[44:47], v[96:99], v[156:159], v[44:47]
v_mfma_f32_16x16x32_bf16 v[36:39], v[100:103], v[144:147], v[36:39]
v_mfma_f32_16x16x32_bf16 v[40:43], v[100:103], v[148:151], v[40:43]
v_mfma_f32_16x16x32_bf16 v[44:47], v[100:103], v[152:155], v[44:47]
v_mfma_f32_16x16x32_bf16 v[40:43], v[104:107], v[144:147], v[40:43]
v_mfma_f32_16x16x32_bf16 v[44:47], v[104:107], v[148:151], v[44:47]
v_mfma_f32_16x16x32_bf16 v[44:47], v[108:111], v[144:147], v[44:47]
s_waitcnt lgkmcnt(0)
v_mfma_f32_16x16x32_bf16 v[16:19], v[48:51], v[112:115], v[16:19]
ds_read2_b32 v[80:81], v2 offset0:80 offset1:81
v_mfma_f32_16x16x32_bf16 v[20:23], v[48:51], v[116:119], v[20:23]
ds_read2_b32 v[82:83], v2 offset0:82 offset1:83
v_mfma_f32_16x16x32_bf16 v[24:27], v[48:51], v[120:123], v[24:27]
ds_read_b128 v[144:147], v13 offset:3904
v_mfma_f32_16x16x32_bf16 v[28:31], v[48:51], v[124:127], v[28:31]
ds_read_b128 v[148:151], v13 offset:3392
v_mfma_f32_16x16x32_bf16 v[32:35], v[48:51], v[128:131], v[32:35]
ds_read_b128 v[152:155], v13 offset:2880
v_mfma_f32_16x16x32_bf16 v[36:39], v[48:51], v[132:135], v[36:39]
ds_read_b128 v[156:159], v13 offset:2368
v_mfma_f32_16x16x32_bf16 v[40:43], v[48:51], v[136:139], v[40:43]
ds_read_b128 v[160:163], v13 offset:1856
v_mfma_f32_16x16x32_bf16 v[44:47], v[48:51], v[140:143], v[44:47]
ds_read_b128 v[164:167], v13 offset:1344
v_mfma_f32_16x16x32_bf16 v[20:23], v[52:55], v[112:115], v[20:23]
ds_read_b128 v[168:171], v13 offset:832
v_mfma_f32_16x16x32_bf16 v[24:27], v[52:55], v[116:119], v[24:27]
ds_read_b128 v[172:175], v13 offset:320
v_mfma_f32_16x16x32_bf16 v[28:31], v[52:55], v[120:123], v[28:31]
ds_read2_b32 v[84:85], v2 offset0:208 offset1:209
v_mfma_f32_16x16x32_bf16 v[32:35], v[52:55], v[124:127], v[32:35]
ds_read2_b32 v[86:87], v2 offset0:210 offset1:211
v_mfma_f32_16x16x32_bf16 v[36:39], v[52:55], v[128:131], v[36:39]
ds_read2_b32 v[88:89], v9 offset0:80 offset1:81
v_mfma_f32_16x16x32_bf16 v[40:43], v[52:55], v[132:135], v[40:43]
ds_read2_b32 v[90:91], v9 offset0:82 offset1:83
v_mfma_f32_16x16x32_bf16 v[44:47], v[52:55], v[136:139], v[44:47]
ds_read2_b32 v[92:93], v9 offset0:208 offset1:209
v_mfma_f32_16x16x32_bf16 v[24:27], v[56:59], v[112:115], v[24:27]
ds_read2_b32 v[94:95], v9 offset0:210 offset1:211
v_mfma_f32_16x16x32_bf16 v[28:31], v[56:59], v[116:119], v[28:31]
ds_read2_b32 v[96:97], v10 offset0:80 offset1:81
v_mfma_f32_16x16x32_bf16 v[32:35], v[56:59], v[120:123], v[32:35]
ds_read2_b32 v[98:99], v10 offset0:82 offset1:83
v_mfma_f32_16x16x32_bf16 v[36:39], v[56:59], v[124:127], v[36:39]
ds_read2_b32 v[100:101], v10 offset0:208 offset1:209
v_mfma_f32_16x16x32_bf16 v[40:43], v[56:59], v[128:131], v[40:43]
ds_read2_b32 v[102:103], v10 offset0:210 offset1:211
v_mfma_f32_16x16x32_bf16 v[44:47], v[56:59], v[132:135], v[44:47]
ds_read2_b32 v[104:105], v12 offset0:80 offset1:81
v_mfma_f32_16x16x32_bf16 v[28:31], v[60:63], v[112:115], v[28:31]
ds_read2_b32 v[106:107], v12 offset0:82 offset1:83
v_mfma_f32_16x16x32_bf16 v[32:35], v[60:63], v[116:119], v[32:35]
ds_read2_b32 v[108:109], v12 offset0:208 offset1:209
v_mfma_f32_16x16x32_bf16 v[36:39], v[60:63], v[120:123], v[36:39]
ds_read2_b32 v[110:111], v12 offset0:210 offset1:211
v_mfma_f32_16x16x32_bf16 v[40:43], v[60:63], v[124:127], v[40:43]
v_mfma_f32_16x16x32_bf16 v[44:47], v[60:63], v[128:131], v[44:47]
v_mfma_f32_16x16x32_bf16 v[32:35], v[64:67], v[112:115], v[32:35]
v_mfma_f32_16x16x32_bf16 v[36:39], v[64:67], v[116:119], v[36:39]
v_mfma_f32_16x16x32_bf16 v[40:43], v[64:67], v[120:123], v[40:43]
v_mfma_f32_16x16x32_bf16 v[44:47], v[64:67], v[124:127], v[44:47]
v_mfma_f32_16x16x32_bf16 v[36:39], v[68:71], v[112:115], v[36:39]
v_mfma_f32_16x16x32_bf16 v[40:43], v[68:71], v[116:119], v[40:43]
v_mfma_f32_16x16x32_bf16 v[44:47], v[68:71], v[120:123], v[44:47]
v_mfma_f32_16x16x32_bf16 v[40:43], v[72:75], v[112:115], v[40:43]
v_mfma_f32_16x16x32_bf16 v[44:47], v[72:75], v[116:119], v[44:47]
v_mfma_f32_16x16x32_bf16 v[44:47], v[76:79], v[112:115], v[44:47]
s_waitcnt lgkmcnt(0)
v_mfma_f32_16x16x32_bf16 v[16:19], v[80:83], v[144:147], v[16:19]
ds_read2_b32 v[48:49], v2 offset0:96 offset1:97
v_mfma_f32_16x16x32_bf16 v[20:23], v[80:83], v[148:151], v[20:23]
ds_read2_b32 v[50:51], v2 offset0:98 offset1:99
v_mfma_f32_16x16x32_bf16 v[24:27], v[80:83], v[152:155], v[24:27]
ds_read_b128 v[112:115], v13 offset:3968
v_mfma_f32_16x16x32_bf16 v[28:31], v[80:83], v[156:159], v[28:31]
ds_read_b128 v[116:119], v13 offset:3456
v_mfma_f32_16x16x32_bf16 v[32:35], v[80:83], v[160:163], v[32:35]
ds_read_b128 v[120:123], v13 offset:2944
v_mfma_f32_16x16x32_bf16 v[36:39], v[80:83], v[164:167], v[36:39]
ds_read_b128 v[124:127], v13 offset:2432
v_mfma_f32_16x16x32_bf16 v[40:43], v[80:83], v[168:171], v[40:43]
ds_read_b128 v[128:131], v13 offset:1920
v_mfma_f32_16x16x32_bf16 v[44:47], v[80:83], v[172:175], v[44:47]
ds_read_b128 v[132:135], v13 offset:1408
v_mfma_f32_16x16x32_bf16 v[20:23], v[84:87], v[144:147], v[20:23]
ds_read_b128 v[136:139], v13 offset:896
v_mfma_f32_16x16x32_bf16 v[24:27], v[84:87], v[148:151], v[24:27]
ds_read_b128 v[140:143], v13 offset:384
v_mfma_f32_16x16x32_bf16 v[28:31], v[84:87], v[152:155], v[28:31]
ds_read2_b32 v[52:53], v2 offset0:224 offset1:225
v_mfma_f32_16x16x32_bf16 v[32:35], v[84:87], v[156:159], v[32:35]
ds_read2_b32 v[54:55], v2 offset0:226 offset1:227
v_mfma_f32_16x16x32_bf16 v[36:39], v[84:87], v[160:163], v[36:39]
ds_read2_b32 v[56:57], v9 offset0:96 offset1:97
v_mfma_f32_16x16x32_bf16 v[40:43], v[84:87], v[164:167], v[40:43]
ds_read2_b32 v[58:59], v9 offset0:98 offset1:99
v_mfma_f32_16x16x32_bf16 v[44:47], v[84:87], v[168:171], v[44:47]
ds_read2_b32 v[60:61], v9 offset0:224 offset1:225
v_mfma_f32_16x16x32_bf16 v[24:27], v[88:91], v[144:147], v[24:27]
ds_read2_b32 v[62:63], v9 offset0:226 offset1:227
v_mfma_f32_16x16x32_bf16 v[28:31], v[88:91], v[148:151], v[28:31]
ds_read2_b32 v[64:65], v10 offset0:96 offset1:97
v_mfma_f32_16x16x32_bf16 v[32:35], v[88:91], v[152:155], v[32:35]
ds_read2_b32 v[66:67], v10 offset0:98 offset1:99
v_mfma_f32_16x16x32_bf16 v[36:39], v[88:91], v[156:159], v[36:39]
ds_read2_b32 v[68:69], v10 offset0:224 offset1:225
v_mfma_f32_16x16x32_bf16 v[40:43], v[88:91], v[160:163], v[40:43]
ds_read2_b32 v[70:71], v10 offset0:226 offset1:227
v_mfma_f32_16x16x32_bf16 v[44:47], v[88:91], v[164:167], v[44:47]
ds_read2_b32 v[72:73], v12 offset0:96 offset1:97
v_mfma_f32_16x16x32_bf16 v[28:31], v[92:95], v[144:147], v[28:31]
ds_read2_b32 v[74:75], v12 offset0:98 offset1:99
v_mfma_f32_16x16x32_bf16 v[32:35], v[92:95], v[148:151], v[32:35]
ds_read2_b32 v[76:77], v12 offset0:224 offset1:225
v_mfma_f32_16x16x32_bf16 v[36:39], v[92:95], v[152:155], v[36:39]
ds_read2_b32 v[78:79], v12 offset0:226 offset1:227
v_mfma_f32_16x16x32_bf16 v[40:43], v[92:95], v[156:159], v[40:43]
v_mfma_f32_16x16x32_bf16 v[44:47], v[92:95], v[160:163], v[44:47]
v_mfma_f32_16x16x32_bf16 v[32:35], v[96:99], v[144:147], v[32:35]
v_mfma_f32_16x16x32_bf16 v[36:39], v[96:99], v[148:151], v[36:39]
v_mfma_f32_16x16x32_bf16 v[40:43], v[96:99], v[152:155], v[40:43]
v_mfma_f32_16x16x32_bf16 v[44:47], v[96:99], v[156:159], v[44:47]
v_mfma_f32_16x16x32_bf16 v[36:39], v[100:103], v[144:147], v[36:39]
v_mfma_f32_16x16x32_bf16 v[40:43], v[100:103], v[148:151], v[40:43]
v_mfma_f32_16x16x32_bf16 v[44:47], v[100:103], v[152:155], v[44:47]
v_mfma_f32_16x16x32_bf16 v[40:43], v[104:107], v[144:147], v[40:43]
v_mfma_f32_16x16x32_bf16 v[44:47], v[104:107], v[148:151], v[44:47]
v_mfma_f32_16x16x32_bf16 v[44:47], v[108:111], v[144:147], v[44:47]
s_waitcnt lgkmcnt(0)
v_mfma_f32_16x16x32_bf16 v[16:19], v[48:51], v[112:115], v[16:19]
ds_read2_b32 v[80:81], v2 offset0:112 offset1:113
v_mfma_f32_16x16x32_bf16 v[20:23], v[48:51], v[116:119], v[20:23]
ds_read2_b32 v[82:83], v2 offset0:114 offset1:115
v_mfma_f32_16x16x32_bf16 v[24:27], v[48:51], v[120:123], v[24:27]
ds_read_b128 v[144:147], v13 offset:4032
v_mfma_f32_16x16x32_bf16 v[28:31], v[48:51], v[124:127], v[28:31]
ds_read_b128 v[148:151], v13 offset:3520
v_mfma_f32_16x16x32_bf16 v[32:35], v[48:51], v[128:131], v[32:35]
ds_read_b128 v[152:155], v13 offset:3008
v_mfma_f32_16x16x32_bf16 v[36:39], v[48:51], v[132:135], v[36:39]
ds_read_b128 v[156:159], v13 offset:2496
v_mfma_f32_16x16x32_bf16 v[40:43], v[48:51], v[136:139], v[40:43]
ds_read_b128 v[160:163], v13 offset:1984
v_mfma_f32_16x16x32_bf16 v[44:47], v[48:51], v[140:143], v[44:47]
ds_read_b128 v[164:167], v13 offset:1472
v_mfma_f32_16x16x32_bf16 v[20:23], v[52:55], v[112:115], v[20:23]
ds_read_b128 v[168:171], v13 offset:960
v_mfma_f32_16x16x32_bf16 v[24:27], v[52:55], v[116:119], v[24:27]
ds_read_b128 v[172:175], v13 offset:448
v_mfma_f32_16x16x32_bf16 v[28:31], v[52:55], v[120:123], v[28:31]
ds_read2_b32 v[84:85], v2 offset0:240 offset1:241
v_mfma_f32_16x16x32_bf16 v[32:35], v[52:55], v[124:127], v[32:35]
ds_read2_b32 v[86:87], v2 offset0:242 offset1:243
v_mfma_f32_16x16x32_bf16 v[36:39], v[52:55], v[128:131], v[36:39]
ds_read2_b32 v[88:89], v9 offset0:112 offset1:113
v_mfma_f32_16x16x32_bf16 v[40:43], v[52:55], v[132:135], v[40:43]
ds_read2_b32 v[90:91], v9 offset0:114 offset1:115
v_mfma_f32_16x16x32_bf16 v[44:47], v[52:55], v[136:139], v[44:47]
ds_read2_b32 v[92:93], v9 offset0:240 offset1:241
v_mfma_f32_16x16x32_bf16 v[24:27], v[56:59], v[112:115], v[24:27]
ds_read2_b32 v[94:95], v9 offset0:242 offset1:243
v_mfma_f32_16x16x32_bf16 v[28:31], v[56:59], v[116:119], v[28:31]
ds_read2_b32 v[96:97], v10 offset0:112 offset1:113
v_mfma_f32_16x16x32_bf16 v[32:35], v[56:59], v[120:123], v[32:35]
ds_read2_b32 v[98:99], v10 offset0:114 offset1:115
v_mfma_f32_16x16x32_bf16 v[36:39], v[56:59], v[124:127], v[36:39]
ds_read2_b32 v[100:101], v10 offset0:240 offset1:241
v_mfma_f32_16x16x32_bf16 v[40:43], v[56:59], v[128:131], v[40:43]
ds_read2_b32 v[102:103], v10 offset0:242 offset1:243
v_mfma_f32_16x16x32_bf16 v[44:47], v[56:59], v[132:135], v[44:47]
ds_read2_b32 v[104:105], v12 offset0:112 offset1:113
v_mfma_f32_16x16x32_bf16 v[28:31], v[60:63], v[112:115], v[28:31]
ds_read2_b32 v[106:107], v12 offset0:114 offset1:115
v_mfma_f32_16x16x32_bf16 v[32:35], v[60:63], v[116:119], v[32:35]
ds_read2_b32 v[108:109], v12 offset0:240 offset1:241
v_mfma_f32_16x16x32_bf16 v[36:39], v[60:63], v[120:123], v[36:39]
ds_read2_b32 v[110:111], v12 offset0:242 offset1:243
v_mfma_f32_16x16x32_bf16 v[40:43], v[60:63], v[124:127], v[40:43]
v_mfma_f32_16x16x32_bf16 v[44:47], v[60:63], v[128:131], v[44:47]
v_mfma_f32_16x16x32_bf16 v[32:35], v[64:67], v[112:115], v[32:35]
v_mfma_f32_16x16x32_bf16 v[36:39], v[64:67], v[116:119], v[36:39]
v_mfma_f32_16x16x32_bf16 v[40:43], v[64:67], v[120:123], v[40:43]
v_mfma_f32_16x16x32_bf16 v[44:47], v[64:67], v[124:127], v[44:47]
v_mfma_f32_16x16x32_bf16 v[36:39], v[68:71], v[112:115], v[36:39]
v_mfma_f32_16x16x32_bf16 v[40:43], v[68:71], v[116:119], v[40:43]
v_mfma_f32_16x16x32_bf16 v[44:47], v[68:71], v[120:123], v[44:47]
v_mfma_f32_16x16x32_bf16 v[40:43], v[72:75], v[112:115], v[40:43]
v_mfma_f32_16x16x32_bf16 v[44:47], v[72:75], v[116:119], v[44:47]
v_mfma_f32_16x16x32_bf16 v[44:47], v[76:79], v[112:115], v[44:47]
s_waitcnt lgkmcnt(0)
v_mfma_f32_16x16x32_bf16 v[16:19], v[80:83], v[144:147], v[16:19]
ds_read_b64 v[48:49], v14 offset:3584
v_mfma_f32_16x16x32_bf16 v[20:23], v[80:83], v[148:151], v[20:23]
ds_read_b64 v[50:51], v14 offset:3072
v_mfma_f32_16x16x32_bf16 v[24:27], v[80:83], v[152:155], v[24:27]
ds_read_b64 v[52:53], v14 offset:2560
v_mfma_f32_16x16x32_bf16 v[28:31], v[80:83], v[156:159], v[28:31]
ds_read_b64 v[54:55], v14 offset:2048
v_mfma_f32_16x16x32_bf16 v[32:35], v[80:83], v[160:163], v[32:35]
ds_read_b64 v[56:57], v14 offset:1536
v_mfma_f32_16x16x32_bf16 v[36:39], v[80:83], v[164:167], v[36:39]
ds_read_b64 v[58:59], v14 offset:1024
v_mfma_f32_16x16x32_bf16 v[40:43], v[80:83], v[168:171], v[40:43]
ds_read_b64 v[60:61], v14 offset:512
v_mfma_f32_16x16x32_bf16 v[44:47], v[80:83], v[172:175], v[44:47]
ds_read_b64 v[62:63], v14 offset:0
v_mfma_f32_16x16x32_bf16 v[20:23], v[84:87], v[144:147], v[20:23]
v_mfma_f32_16x16x32_bf16 v[24:27], v[84:87], v[148:151], v[24:27]
v_mfma_f32_16x16x32_bf16 v[28:31], v[84:87], v[152:155], v[28:31]
v_mfma_f32_16x16x32_bf16 v[32:35], v[84:87], v[156:159], v[32:35]
v_mfma_f32_16x16x32_bf16 v[36:39], v[84:87], v[160:163], v[36:39]
v_mfma_f32_16x16x32_bf16 v[40:43], v[84:87], v[164:167], v[40:43]
v_mfma_f32_16x16x32_bf16 v[44:47], v[84:87], v[168:171], v[44:47]
v_mfma_f32_16x16x32_bf16 v[24:27], v[88:91], v[144:147], v[24:27]
v_mfma_f32_16x16x32_bf16 v[28:31], v[88:91], v[148:151], v[28:31]
v_mfma_f32_16x16x32_bf16 v[32:35], v[88:91], v[152:155], v[32:35]
v_mfma_f32_16x16x32_bf16 v[36:39], v[88:91], v[156:159], v[36:39]
v_mfma_f32_16x16x32_bf16 v[40:43], v[88:91], v[160:163], v[40:43]
v_mfma_f32_16x16x32_bf16 v[44:47], v[88:91], v[164:167], v[44:47]
v_mfma_f32_16x16x32_bf16 v[28:31], v[92:95], v[144:147], v[28:31]
v_mfma_f32_16x16x32_bf16 v[32:35], v[92:95], v[148:151], v[32:35]
v_mfma_f32_16x16x32_bf16 v[36:39], v[92:95], v[152:155], v[36:39]
v_mfma_f32_16x16x32_bf16 v[40:43], v[92:95], v[156:159], v[40:43]
v_mfma_f32_16x16x32_bf16 v[44:47], v[92:95], v[160:163], v[44:47]
v_mfma_f32_16x16x32_bf16 v[32:35], v[96:99], v[144:147], v[32:35]
v_mfma_f32_16x16x32_bf16 v[36:39], v[96:99], v[148:151], v[36:39]
v_mfma_f32_16x16x32_bf16 v[40:43], v[96:99], v[152:155], v[40:43]
v_mfma_f32_16x16x32_bf16 v[44:47], v[96:99], v[156:159], v[44:47]
v_mfma_f32_16x16x32_bf16 v[36:39], v[100:103], v[144:147], v[36:39]
v_mfma_f32_16x16x32_bf16 v[40:43], v[100:103], v[148:151], v[40:43]
v_mfma_f32_16x16x32_bf16 v[44:47], v[100:103], v[152:155], v[44:47]
v_mfma_f32_16x16x32_bf16 v[40:43], v[104:107], v[144:147], v[40:43]
v_mfma_f32_16x16x32_bf16 v[44:47], v[104:107], v[148:151], v[44:47]
v_mfma_f32_16x16x32_bf16 v[44:47], v[108:111], v[144:147], v[44:47]
s_waitcnt lgkmcnt(0)
v_and_b32 v80, s53, v49
v_lshlrev_b32 v81, 16, v49
v_and_b32 v82, s53, v48
v_lshlrev_b32 v83, 16, v48
v_pk_fma_f32 v[112:113], v[80:81], s[60:61], v[16:17] op_sel_hi:[1,0,1]
v_pk_fma_f32 v[114:115], v[82:83], s[60:61], v[18:19] op_sel_hi:[1,0,1]
ds_write_b128 v15, v[112:115] offset:0
v_and_b32 v84, s53, v51
v_lshlrev_b32 v85, 16, v51
v_and_b32 v86, s53, v50
v_lshlrev_b32 v87, 16, v50
v_pk_fma_f32 v[116:117], v[84:85], s[60:61], v[20:21] op_sel_hi:[1,0,1]
v_pk_fma_f32 v[118:119], v[86:87], s[60:61], v[22:23] op_sel_hi:[1,0,1]
ds_write_b128 v15, v[116:119] offset:1024
v_and_b32 v80, s53, v53
v_lshlrev_b32 v81, 16, v53
v_and_b32 v82, s53, v52
v_lshlrev_b32 v83, 16, v52
v_pk_fma_f32 v[120:121], v[80:81], s[60:61], v[24:25] op_sel_hi:[1,0,1]
v_pk_fma_f32 v[122:123], v[82:83], s[60:61], v[26:27] op_sel_hi:[1,0,1]
ds_write_b128 v15, v[120:123] offset:2048
v_and_b32 v84, s53, v55
v_lshlrev_b32 v85, 16, v55
v_and_b32 v86, s53, v54
v_lshlrev_b32 v87, 16, v54
v_pk_fma_f32 v[124:125], v[84:85], s[60:61], v[28:29] op_sel_hi:[1,0,1]
v_pk_fma_f32 v[126:127], v[86:87], s[60:61], v[30:31] op_sel_hi:[1,0,1]
ds_write_b128 v15, v[124:127] offset:3072
v_and_b32 v80, s53, v57
v_lshlrev_b32 v81, 16, v57
v_and_b32 v82, s53, v56
v_lshlrev_b32 v83, 16, v56
v_pk_fma_f32 v[128:129], v[80:81], s[60:61], v[32:33] op_sel_hi:[1,0,1]
v_pk_fma_f32 v[130:131], v[82:83], s[60:61], v[34:35] op_sel_hi:[1,0,1]
ds_write_b128 v15, v[128:131] offset:4096
v_and_b32 v84, s53, v59
v_lshlrev_b32 v85, 16, v59
v_and_b32 v86, s53, v58
v_lshlrev_b32 v87, 16, v58
v_pk_fma_f32 v[132:133], v[84:85], s[60:61], v[36:37] op_sel_hi:[1,0,1]
v_pk_fma_f32 v[134:135], v[86:87], s[60:61], v[38:39] op_sel_hi:[1,0,1]
ds_write_b128 v15, v[132:135] offset:5120
v_and_b32 v80, s53, v61
v_lshlrev_b32 v81, 16, v61
v_and_b32 v82, s53, v60
v_lshlrev_b32 v83, 16, v60
v_pk_fma_f32 v[136:137], v[80:81], s[60:61], v[40:41] op_sel_hi:[1,0,1]
v_pk_fma_f32 v[138:139], v[82:83], s[60:61], v[42:43] op_sel_hi:[1,0,1]
ds_write_b128 v15, v[136:139] offset:6144
v_and_b32 v84, s53, v63
v_lshlrev_b32 v85, 16, v63
v_and_b32 v86, s53, v62
v_lshlrev_b32 v87, 16, v62
v_pk_fma_f32 v[140:141], v[84:85], s[60:61], v[44:45] op_sel_hi:[1,0,1]
v_pk_fma_f32 v[142:143], v[86:87], s[60:61], v[46:47] op_sel_hi:[1,0,1]
ds_write_b128 v15, v[140:143] offset:7168
s_waitcnt vmcnt(0)
v_lshlrev_b32 v48, 16, v176
v_and_b32 v50, s53, v176
v_lshlrev_b32 v52, 16, v177
v_and_b32 v54, s53, v177
v_lshlrev_b32 v49, 16, v178
v_and_b32 v51, s53, v178
v_lshlrev_b32 v53, 16, v179
v_and_b32 v55, s53, v179
v_lshlrev_b32 v56, 16, v180
v_and_b32 v58, s53, v180
v_lshlrev_b32 v60, 16, v181
v_and_b32 v62, s53, v181
v_lshlrev_b32 v57, 16, v182
v_and_b32 v59, s53, v182
v_lshlrev_b32 v61, 16, v183
v_and_b32 v63, s53, v183
v_lshlrev_b32 v64, 16, v184
v_and_b32 v66, s53, v184
v_lshlrev_b32 v68, 16, v185
v_and_b32 v70, s53, v185
v_lshlrev_b32 v65, 16, v186
v_and_b32 v67, s53, v186
v_lshlrev_b32 v69, 16, v187
v_and_b32 v71, s53, v187
v_lshlrev_b32 v72, 16, v188
v_and_b32 v74, s53, v188
v_lshlrev_b32 v76, 16, v189
v_and_b32 v78, s53, v189
v_lshlrev_b32 v73, 16, v190
v_and_b32 v75, s53, v190
v_lshlrev_b32 v77, 16, v191
v_and_b32 v79, s53, v191
v_pk_fma_f32 v[80:81], v[48:49], v[192:193], v[194:195]
v_pk_fma_f32 v[82:83], v[50:51], v[192:193], v[194:195]
v_pk_fma_f32 v[84:85], v[52:53], v[192:193], v[194:195]
v_pk_fma_f32 v[86:87], v[54:55], v[192:193], v[194:195]
v_pk_fma_f32 v[88:89], v[56:57], v[196:197], v[198:199]
v_pk_fma_f32 v[90:91], v[58:59], v[196:197], v[198:199]
v_pk_fma_f32 v[92:93], v[60:61], v[196:197], v[198:199]
v_pk_fma_f32 v[94:95], v[62:63], v[196:197], v[198:199]
v_pk_fma_f32 v[96:97], v[64:65], v[200:201], v[202:203]
v_pk_fma_f32 v[98:99], v[66:67], v[200:201], v[202:203]
v_pk_fma_f32 v[100:101], v[68:69], v[200:201], v[202:203]
v_pk_fma_f32 v[102:103], v[70:71], v[200:201], v[202:203]
v_pk_fma_f32 v[104:105], v[72:73], v[204:205], v[206:207]
v_pk_fma_f32 v[106:107], v[74:75], v[204:205], v[206:207]
v_pk_fma_f32 v[108:109], v[76:77], v[204:205], v[206:207]
v_pk_fma_f32 v[110:111], v[78:79], v[204:205], v[206:207]
s_waitcnt lgkmcnt(0)
v_mov_b32 v210, 1
s_mov_b64 s[62:63], exec
s_mov_b64 exec, 1
ds_add_u32 v209, v210
s_mov_b64 exec, s[62:63]
K1_RDV:
ds_read_b32 v210, v209
s_waitcnt lgkmcnt(0)
v_readfirstlane_b32 s62, v210
s_nop 3
s_cmp_lt_u32 s62, 4
s_cbranch_scc1 K1_RDV
ds_read_b64 v[112:113], v208 offset:0
ds_read_b64 v[114:115], v208 offset:12928
ds_read_b64 v[116:117], v208 offset:25856
ds_read_b64 v[118:119], v208 offset:38784
ds_read_b64 v[120:121], v208 offset:512
ds_read_b64 v[122:123], v208 offset:13440
ds_read_b64 v[124:125], v208 offset:26368
ds_read_b64 v[126:127], v208 offset:39296
ds_read_b64 v[128:129], v208 offset:1024
ds_read_b64 v[130:131], v208 offset:13952
ds_read_b64 v[132:133], v208 offset:26880
ds_read_b64 v[134:135], v208 offset:39808
ds_read_b64 v[136:137], v208 offset:1536
ds_read_b64 v[138:139], v208 offset:14464
ds_read_b64 v[140:141], v208 offset:27392
ds_read_b64 v[142:143], v208 offset:40320
s_waitcnt lgkmcnt(12)
v_pk_fma_f32 v[80:81], v[80:81], v[112:113], v[48:49]
v_pk_fma_f32 v[82:83], v[82:83], v[114:115], v[50:51]
v_pk_fma_f32 v[84:85], v[84:85], v[116:117], v[52:53]
v_pk_fma_f32 v[86:87], v[86:87], v[118:119], v[54:55]
v_cvt_pk_bf16_f32 v144, v80, v82
v_cvt_pk_bf16_f32 v145, v84, v86
v_cvt_pk_bf16_f32 v146, v81, v83
v_cvt_pk_bf16_f32 v147, v85, v87
buffer_store_dwordx4 v[144:147], v7, s[32:35], s49 offen offset:0 sc1
s_waitcnt lgkmcnt(8)
v_pk_fma_f32 v[88:89], v[88:89], v[120:121], v[56:57]
v_pk_fma_f32 v[90:91], v[90:91], v[122:123], v[58:59]
v_pk_fma_f32 v[92:93], v[92:93], v[124:125], v[60:61]
v_pk_fma_f32 v[94:95], v[94:95], v[126:127], v[62:63]
v_cvt_pk_bf16_f32 v148, v88, v90
v_cvt_pk_bf16_f32 v149, v92, v94
v_cvt_pk_bf16_f32 v150, v89, v91
v_cvt_pk_bf16_f32 v151, v93, v95
buffer_store_dwordx4 v[148:151], v7, s[32:35], s49 offen offset:1024 sc1
s_waitcnt lgkmcnt(4)
v_pk_fma_f32 v[96:97], v[96:97], v[128:129], v[64:65]
v_pk_fma_f32 v[98:99], v[98:99], v[130:131], v[66:67]
v_pk_fma_f32 v[100:101], v[100:101], v[132:133], v[68:69]
v_pk_fma_f32 v[102:103], v[102:103], v[134:135], v[70:71]
v_cvt_pk_bf16_f32 v152, v96, v98
v_cvt_pk_bf16_f32 v153, v100, v102
v_cvt_pk_bf16_f32 v154, v97, v99
v_cvt_pk_bf16_f32 v155, v101, v103
buffer_store_dwordx4 v[152:155], v7, s[32:35], s49 offen offset:2048 sc1
s_waitcnt lgkmcnt(0)
v_pk_fma_f32 v[104:105], v[104:105], v[136:137], v[72:73]
v_pk_fma_f32 v[106:107], v[106:107], v[138:139], v[74:75]
v_pk_fma_f32 v[108:109], v[108:109], v[140:141], v[76:77]
v_pk_fma_f32 v[110:111], v[110:111], v[142:143], v[78:79]
v_cvt_pk_bf16_f32 v156, v104, v106
v_cvt_pk_bf16_f32 v157, v108, v110
v_cvt_pk_bf16_f32 v158, v105, v107
v_cvt_pk_bf16_f32 v159, v109, v111
buffer_store_dwordx4 v[156:159], v7, s[32:35], s49 offen offset:3072 sc1
s_endpgm
K1_HELP:
s_sub_u32 s50, s44, 4
v_lshlrev_b32 v2, 4, v1
s_mul_i32 s55, s2, 4682
s_lshr_b32 s55, s55, 16
s_mul_i32 s56, s55, 14
s_sub_u32 s56, s2, s56
v_and_b32 v9, 7, v1
v_lshrrev_b32 v10, 3, v1
v_mul_u32_u24 v11, 57344, v10
v_lshl_add_u32 v11, v9, 4, v11
s_mul_i32 s57, s55, 458752
s_lshl_b32 s58, s56, 9
s_add_u32 s57, s57, s58
s_lshl_b32 s58, s50, 7
s_add_u32 s57, s57, s58
s_mul_i32 s66, s50, 7
s_mul_i32 s67, s2, 14
s_mov_b32 s64, 458752
v_mul_lo_u32 v13, v10, s64
v_lshl_add_u32 v13, v9, 4, v13
s_waitcnt lgkmcnt(0)
s_mov_b32 s36, s8
s_mov_b32 s37, s9
s_mov_b32 s38, 0x700000
s_mov_b32 s39, 0x20000
s_add_u32 s40, s12, 0x1410000
s_addc_u32 s41, s13, 0
s_mov_b32 s42, 0x38000
s_mov_b32 s43, 0x20000
s_add_u32 s28, s12, 0x3800000
s_addc_u32 s29, s13, 0
s_mov_b32 s30, 0x700000
s_mov_b32 s31, 0x20000
s_barrier
s_add_u32 s58, s57, 0
buffer_load_dwordx4 v[16:19], v11, s[36:39], s58 offen
s_add_u32 s58, s57, 7168
buffer_load_dwordx4 v[20:23], v11, s[36:39], s58 offen
s_add_u32 s58, s57, 14336
buffer_load_dwordx4 v[24:27], v11, s[36:39], s58 offen
s_add_u32 s58, s57, 21504
buffer_load_dwordx4 v[28:31], v11, s[36:39], s58 offen
s_add_u32 s58, s57, 28672
buffer_load_dwordx4 v[32:35], v11, s[36:39], s58 offen
s_add_u32 s58, s57, 35840
buffer_load_dwordx4 v[36:39], v11, s[36:39], s58 offen
s_add_u32 s58, s57, 43008
buffer_load_dwordx4 v[40:43], v11, s[36:39], s58 offen
s_add_u32 s58, s57, 50176
buffer_load_dwordx4 v[44:47], v11, s[36:39], s58 offen
s_waitcnt vmcnt(0)
s_mov_b32 s53, 0xffff0000
v_lshlrev_b32 v80, 16, v16
v_and_b32 v81, s53, v16
v_lshlrev_b32 v82, 16, v17
v_and_b32 v83, s53, v17
v_lshlrev_b32 v84, 16, v18
v_and_b32 v85, s53, v18
v_lshlrev_b32 v86, 16, v19
v_and_b32 v87, s53, v19
v_lshlrev_b32 v88, 16, v20
v_and_b32 v89, s53, v20
v_add_f32 v80, v80, v88
v_add_f32 v81, v81, v89
v_lshlrev_b32 v90, 16, v21
v_and_b32 v91, s53, v21
v_add_f32 v82, v82, v90
v_add_f32 v83, v83, v91
v_lshlrev_b32 v88, 16, v22
v_and_b32 v89, s53, v22
v_add_f32 v84, v84, v88
v_add_f32 v85, v85, v89
v_lshlrev_b32 v90, 16, v23
v_and_b32 v91, s53, v23
v_add_f32 v86, v86, v90
v_add_f32 v87, v87, v91
v_lshlrev_b32 v88, 16, v24
v_and_b32 v89, s53, v24
v_add_f32 v80, v80, v88
v_add_f32 v81, v81, v89
v_lshlrev_b32 v90, 16, v25
v_and_b32 v91, s53, v25
v_add_f32 v82, v82, v90
v_add_f32 v83, v83, v91
v_lshlrev_b32 v88, 16, v26
v_and_b32 v89, s53, v26
v_add_f32 v84, v84, v88
v_add_f32 v85, v85, v89
v_lshlrev_b32 v90, 16, v27
v_and_b32 v91, s53, v27
v_add_f32 v86, v86, v90
v_add_f32 v87, v87, v91
v_lshlrev_b32 v88, 16, v28
v_and_b32 v89, s53, v28
v_add_f32 v80, v80, v88
v_add_f32 v81, v81, v89
v_lshlrev_b32 v90, 16, v29
v_and_b32 v91, s53, v29
v_add_f32 v82, v82, v90
v_add_f32 v83, v83, v91
v_lshlrev_b32 v88, 16, v30
v_and_b32 v89, s53, v30
v_add_f32 v84, v84, v88
v_add_f32 v85, v85, v89
v_lshlrev_b32 v90, 16, v31
v_and_b32 v91, s53, v31
v_add_f32 v86, v86, v90
v_add_f32 v87, v87, v91
v_lshlrev_b32 v88, 16, v32
v_and_b32 v89, s53, v32
v_add_f32 v80, v80, v88
v_add_f32 v81, v81, v89
v_lshlrev_b32 v90, 16, v33
v_and_b32 v91, s53, v33
v_add_f32 v82, v82, v90
v_add_f32 v83, v83, v91
v_lshlrev_b32 v88, 16, v34
v_and_b32 v89, s53, v34
v_add_f32 v84, v84, v88
v_add_f32 v85, v85, v89
v_lshlrev_b32 v90, 16, v35
v_and_b32 v91, s53, v35
v_add_f32 v86, v86, v90
v_add_f32 v87, v87, v91
v_lshlrev_b32 v88, 16, v36
v_and_b32 v89, s53, v36
v_add_f32 v80, v80, v88
v_add_f32 v81, v81, v89
v_lshlrev_b32 v90, 16, v37
v_and_b32 v91, s53, v37
v_add_f32 v82, v82, v90
v_add_f32 v83, v83, v91
v_lshlrev_b32 v88, 16, v38
v_and_b32 v89, s53, v38
v_add_f32 v84, v84, v88
v_add_f32 v85, v85, v89
v_lshlrev_b32 v90, 16, v39
v_and_b32 v91, s53, v39
v_add_f32 v86, v86, v90
v_add_f32 v87, v87, v91
v_lshlrev_b32 v88, 16, v40
v_and_b32 v89, s53, v40
v_add_f32 v80, v80, v88
v_add_f32 v81, v81, v89
v_lshlrev_b32 v90, 16, v41
v_and_b32 v91, s53, v41
v_add_f32 v82, v82, v90
v_add_f32 v83, v83, v91
v_lshlrev_b32 v88, 16, v42
v_and_b32 v89, s53, v42
v_add_f32 v84, v84, v88
v_add_f32 v85, v85, v89
v_lshlrev_b32 v90, 16, v43
v_and_b32 v91, s53, v43
v_add_f32 v86, v86, v90
v_add_f32 v87, v87, v91
v_lshlrev_b32 v88, 16, v44
v_and_b32 v89, s53, v44
v_add_f32 v80, v80, v88
v_add_f32 v81, v81, v89
v_lshlrev_b32 v90, 16, v45
v_and_b32 v91, s53, v45
v_add_f32 v82, v82, v90
v_add_f32 v83, v83, v91
v_lshlrev_b32 v88, 16, v46
v_and_b32 v89, s53, v46
v_add_f32 v84, v84, v88
v_add_f32 v85, v85, v89
v_lshlrev_b32 v90, 16, v47
v_and_b32 v91, s53, v47
v_add_f32 v86, v86, v90
v_add_f32 v87, v87, v91
v_add_f32_dpp v80, v80, v80 row_ror:8 row_mask:0xf bank_mask:0xf
v_add_f32_dpp v81, v81, v81 row_ror:8 row_mask:0xf bank_mask:0xf
v_add_f32_dpp v82, v82, v82 row_ror:8 row_mask:0xf bank_mask:0xf
v_add_f32_dpp v83, v83, v83 row_ror:8 row_mask:0xf bank_mask:0xf
v_add_f32_dpp v84, v84, v84 row_ror:8 row_mask:0xf bank_mask:0xf
v_add_f32_dpp v85, v85, v85 row_ror:8 row_mask:0xf bank_mask:0xf
v_add_f32_dpp v86, v86, v86 row_ror:8 row_mask:0xf bank_mask:0xf
v_add_f32_dpp v87, v87, v87 row_ror:8 row_mask:0xf bank_mask:0xf
v_mov_b32 v92, v80
v_mov_b32 v93, v81
v_mov_b32 v94, v82
v_mov_b32 v95, v83
v_mov_b32 v96, v84
v_mov_b32 v97, v85
v_mov_b32 v98, v86
v_mov_b32 v99, v87
v_permlane16_swap_b32 v80, v92
v_permlane16_swap_b32 v81, v93
v_permlane16_swap_b32 v82, v94
v_permlane16_swap_b32 v83, v95
v_permlane16_swap_b32 v84, v96
v_permlane16_swap_b32 v85, v97
v_permlane16_swap_b32 v86, v98
v_permlane16_swap_b32 v87, v99
v_add_f32 v80, v80, v92
v_add_f32 v81, v81, v93
v_add_f32 v82, v82, v94
v_add_f32 v83, v83, v95
v_add_f32 v84, v84, v96
v_add_f32 v85, v85, v97
v_add_f32 v86, v86, v98
v_add_f32 v87, v87, v99
v_mov_b32 v92, v80
v_mov_b32 v93, v81
v_mov_b32 v94, v82
v_mov_b32 v95, v83
v_mov_b32 v96, v84
v_mov_b32 v97, v85
v_mov_b32 v98, v86
v_mov_b32 v99, v87
v_permlane32_swap_b32 v80, v92
v_permlane32_swap_b32 v81, v93
v_permlane32_swap_b32 v82, v94
v_permlane32_swap_b32 v83, v95
v_permlane32_swap_b32 v84, v96
v_permlane32_swap_b32 v85, v97
v_permlane32_swap_b32 v86, v98
v_permlane32_swap_b32 v87, v99
v_add_f32 v80, v80, v92
v_add_f32 v81, v81, v93
v_add_f32 v82, v82, v94
v_add_f32 v83, v83, v95
v_add_f32 v84, v84, v96
v_add_f32 v85, v85, v97
v_add_f32 v86, v86, v98
v_add_f32 v87, v87, v99
v_lshlrev_b32 v14, 5, v9
s_mul_i32 s57, s55, 14336
s_lshl_b32 s58, s56, 10
s_add_u32 s57, s57, s58
s_lshl_b32 s58, s50, 8
s_add_u32 s57, s57, s58
s_mov_b64 s[62:63], exec
s_mov_b64 exec, 0xff
buffer_store_dwordx4 v[80:83], v14, s[40:43], s57 offen sc1
buffer_store_dwordx4 v[84:87], v14, s[40:43], s57 offen offset:16 sc1
s_mov_b64 exec, s[62:63]
s_cmp_lg_u32 s44, 4
s_cbranch_scc1 CPFSKIP_g1
s_getpc_b64 s[60:61]
CPF_g1:
s_add_u32 s60, s60, CODE_G1_S-CPF_g1
s_addc_u32 s61, s61, 0
s_lshr_b32 s62, s2, 3
s_mul_i32 s62, s62, 704
s_min_u32 s63, s62, CODE_G1_E-CODE_G1_S-4
s_load_dword s96, s[60:61], s63
s_add_u32 s62, s62, 64
s_min_u32 s63, s62, CODE_G1_E-CODE_G1_S-4
s_load_dword s97, s[60:61], s63
s_add_u32 s62, s62, 64
s_min_u32 s63, s62, CODE_G1_E-CODE_G1_S-4
s_load_dword s98, s[60:61], s63
s_add_u32 s62, s62, 64
s_min_u32 s63, s62, CODE_G1_E-CODE_G1_S-4
s_load_dword s99, s[60:61], s63
s_add_u32 s62, s62, 64
s_min_u32 s63, s62, CODE_G1_E-CODE_G1_S-4
s_load_dword s96, s[60:61], s63
s_add_u32 s62, s62, 64
s_min_u32 s63, s62, CODE_G1_E-CODE_G1_S-4
s_load_dword s97, s[60:61], s63
s_add_u32 s62, s62, 64
s_min_u32 s63, s62, CODE_G1_E-CODE_G1_S-4
s_load_dword s98, s[60:61], s63
s_add_u32 s62, s62, 64
s_min_u32 s63, s62, CODE_G1_E-CODE_G1_S-4
s_load_dword s99, s[60:61], s63
s_add_u32 s62, s62, 64
s_min_u32 s63, s62, CODE_G1_E-CODE_G1_S-4
s_load_dword s96, s[60:61], s63
s_add_u32 s62, s62, 64
s_min_u32 s63, s62, CODE_G1_E-CODE_G1_S-4
s_load_dword s97, s[60:61], s63
s_add_u32 s62, s62, 64
s_min_u32 s63, s62, CODE_G1_E-CODE_G1_S-4
s_load_dword s98, s[60:61], s63
s_add_u32 s62, s62, 64
CPFSKIP_g1:
s_waitcnt vmcnt(2)
s_endpgm
CODE_K1_E:
K1_END:
s_endpgm

.text
.globl gz_kernel
.p2align 8
.type gz_kernel,@function
gz_kernel:
s_cmp_ge_u32 s2, 256
s_cbranch_scc1 GZ_END
CODE_G1_S:
s_load_dwordx4 s[4:7], s[0:1], 56
s_load_dwordx2 s[8:9], s[0:1], 72
s_load_dwordx2 s[12:13], s[0:1], 104
s_load_dwordx2 s[14:15], s[0:1], 80
s_load_dwordx2 s[10:11], s[0:1], 88
v_and_b32 v1, 63, v0
v_lshrrev_b32 v2, 6, v0
s_nop 0
v_readfirstlane_b32 s44, v2
s_and_b32 s47, s2, 7
s_lshr_b32 s48, s2, 3
s_lshr_b32 s45, s47, 1
s_lshl_b32 s45, s45, 2
s_and_b32 s49, s48, 3
s_add_u32 s45, s45, s49
s_and_b32 s46, s47, 1
s_lshl_b32 s46, s46, 3
s_lshr_b32 s49, s48, 2
s_add_u32 s46, s46, s49
s_and_b32 s47, s44, 1
s_bfe_u32 s48, s44, 0x10001
s_cmp_ge_u32 s44, 4
s_cbranch_scc1 G1_DMA
v_lshrrev_b32 v12, 4, v1
v_and_b32 v13, 15, v1
v_mul_u32_u24 v14, 1152, v12
v_lshl_add_u32 v14, v13, 3, v14
s_lshl_b32 s64, s47, 9
s_lshl_b32 s65, s48, 8
s_add_u32 s66, s64, s65
s_sub_u32 s67, s64, s65
v_add_u32 v2, s66, v14
v_add_u32 v11, s67, v14
v_lshrrev_b32 v14, 2, v13
v_lshl_add_u32 v14, v12, 2, v14
v_mul_u32_u24 v14, 448, v14
v_and_b32 v15, 3, v1
v_lshl_add_u32 v14, v15, 3, v14
v_add_u32 v14, 18432, v14
v_and_b32 v15, 1, v12
s_lshl_b32 s84, s48, 3
s_add_u32 s85, s84, 1
s_add_u32 s86, s84, 2
s_add_u32 s87, s84, 3
s_add_u32 s88, s84, 4
s_add_u32 s89, s84, 5
s_mov_b32 s90, 6
s_mov_b32 s91, 7
v_xor_b32 v13, s84, v15
v_lshl_add_u32 v3, v13, 5, v14
v_xor_b32 v13, s85, v15
v_lshl_add_u32 v4, v13, 5, v14
v_xor_b32 v13, s86, v15
v_lshl_add_u32 v5, v13, 5, v14
v_xor_b32 v13, s87, v15
v_lshl_add_u32 v6, v13, 5, v14
v_xor_b32 v13, s88, v15
v_lshl_add_u32 v7, v13, 5, v14
v_xor_b32 v13, s89, v15
v_lshl_add_u32 v8, v13, 5, v14
v_xor_b32 v13, s90, v15
v_lshl_add_u32 v9, v13, 5, v14
v_xor_b32 v13, s91, v15
v_lshl_add_u32 v10, v13, 5, v14
v_mov_b32 v112, 0
v_mov_b32 v113, 0
v_mov_b32 v114, 0
v_mov_b32 v115, 0
v_mov_b32 v116, 0
v_mov_b32 v117, 0
v_mov_b32 v118, 0
v_mov_b32 v119, 0
v_mov_b32 v120, 0
v_mov_b32 v121, 0
v_mov_b32 v122, 0
v_mov_b32 v123, 0
v_mov_b32 v124, 0
v_mov_b32 v125, 0
v_mov_b32 v126, 0
v_mov_b32 v127, 0
v_mov_b32 v128, 0
v_mov_b32 v129, 0
v_mov_b32 v130, 0
v_mov_b32 v131, 0
v_mov_b32 v132, 0
v_mov_b32 v133, 0
v_mov_b32 v134, 0
v_mov_b32 v135, 0
v_mov_b32 v136, 0
v_mov_b32 v137, 0
v_mov_b32 v138, 0
v_mov_b32 v139, 0
v_mov_b32 v140, 0
v_mov_b32 v141, 0
v_mov_b32 v142, 0
v_mov_b32 v143, 0
v_mov_b32 v144, 0
v_mov_b32 v145, 0
v_mov_b32 v146, 0
v_mov_b32 v147, 0
v_mov_b32 v148, 0
v_mov_b32 v149, 0
v_mov_b32 v150, 0
v_mov_b32 v151, 0
v_mov_b32 v152, 0
v_mov_b32 v153, 0
v_mov_b32 v154, 0
v_mov_b32 v155, 0
v_mov_b32 v156, 0
v_mov_b32 v157, 0
v_mov_b32 v158, 0
v_mov_b32 v159, 0
v_mov_b32 v160, 0
v_mov_b32 v161, 0
v_mov_b32 v162, 0
v_mov_b32 v163, 0
v_mov_b32 v164, 0
v_mov_b32 v165, 0
v_mov_b32 v166, 0
v_mov_b32 v167, 0
v_mov_b32 v168, 0
v_mov_b32 v169, 0
v_mov_b32 v170, 0
v_mov_b32 v171, 0
v_mov_b32 v172, 0
v_mov_b32 v173, 0
v_mov_b32 v174, 0
v_mov_b32 v175, 0
v_mov_b32 v176, 0
v_mov_b32 v177, 0
v_mov_b32 v178, 0
v_mov_b32 v179, 0
v_mov_b32 v180, 0
v_mov_b32 v181, 0
v_mov_b32 v182, 0
v_mov_b32 v183, 0
v_mov_b32 v184, 0
v_mov_b32 v185, 0
v_mov_b32 v186, 0
v_mov_b32 v187, 0
v_mov_b32 v188, 0
v_mov_b32 v189, 0
v_mov_b32 v190, 0
v_mov_b32 v191, 0
v_mov_b32 v192, 0
v_mov_b32 v193, 0
v_mov_b32 v194, 0
v_mov_b32 v195, 0
v_mov_b32 v196, 0
v_mov_b32 v197, 0
v_mov_b32 v198, 0
v_mov_b32 v199, 0
v_mov_b32 v200, 0
v_mov_b32 v201, 0
v_mov_b32 v202, 0
v_mov_b32 v203, 0
v_mov_b32 v204, 0
v_mov_b32 v205, 0
v_mov_b32 v206, 0
v_mov_b32 v207, 0
v_mov_b32 v208, 0
v_mov_b32 v209, 0
v_mov_b32 v210, 0
v_mov_b32 v211, 0
v_mov_b32 v212, 0
v_mov_b32 v213, 0
v_mov_b32 v214, 0
v_mov_b32 v215, 0
v_mov_b32 v216, 0
v_mov_b32 v217, 0
v_mov_b32 v218, 0
v_mov_b32 v219, 0
v_mov_b32 v220, 0
v_mov_b32 v221, 0
v_mov_b32 v222, 0
v_mov_b32 v223, 0
v_and_b32 v13, 15, v1
v_lshlrev_b32 v13, 3, v13
s_lshl_b32 s64, s45, 10
s_lshl_b32 s65, s47, 9
s_add_u32 s64, s64, s65
s_lshl_b32 s65, s48, 8
s_add_u32 s62, s64, s65
s_sub_u32 s63, s64, s65
s_add_u32 s63, s63, 256
s_waitcnt lgkmcnt(0)
s_mov_b32 s32, s12
s_mov_b32 s33, s13
s_mov_b32 s34, 0xe00000
s_mov_b32 s35, 0x20000
s_add_u32 s36, s12, 0x1408000
s_addc_u32 s37, s13, 0
s_mov_b32 s38, 0x4000
s_mov_b32 s39, 0x20000
s_mov_b32 s68, s8
s_mov_b32 s69, s9
s_barrier
ds_read_b64_tr_b16 v[32:33], v3 offset:0
ds_read_b64_tr_b16 v[34:35], v3 offset:7168
ds_read_b64 v[16:17], v2 offset:0
ds_read_b64 v[18:19], v2 offset:4608
ds_read_b64 v[20:21], v2 offset:128
ds_read_b64 v[22:23], v2 offset:4736
ds_read_b64 v[24:25], v11 offset:256
ds_read_b64 v[26:27], v11 offset:4864
ds_read_b64 v[28:29], v11 offset:384
ds_read_b64 v[30:31], v11 offset:4992
ds_read_b64_tr_b16 v[36:37], v4 offset:0
ds_read_b64_tr_b16 v[38:39], v4 offset:7168
ds_read_b64_tr_b16 v[40:41], v5 offset:0
ds_read_b64_tr_b16 v[42:43], v5 offset:7168
ds_read_b64_tr_b16 v[44:45], v6 offset:0
ds_read_b64_tr_b16 v[46:47], v6 offset:7168
ds_read_b64_tr_b16 v[48:49], v7 offset:0
ds_read_b64_tr_b16 v[50:51], v7 offset:7168
ds_read_b64_tr_b16 v[52:53], v8 offset:0
ds_read_b64_tr_b16 v[54:55], v8 offset:7168
ds_read_b64_tr_b16 v[56:57], v9 offset:0
ds_read_b64_tr_b16 v[58:59], v9 offset:7168
ds_read_b64_tr_b16 v[60:61], v10 offset:0
ds_read_b64_tr_b16 v[62:63], v10 offset:7168
s_waitcnt lgkmcnt(0)
s_mov_b32 s49, 5
G1A_LOOP:
v_mfma_f32_16x16x32_bf16 v[112:115], v[32:35], v[16:19], v[112:115]
ds_read_b64_tr_b16 v[80:81], v3 offset:14336
ds_read_b64_tr_b16 v[82:83], v3 offset:21504
v_mfma_f32_16x16x32_bf16 v[116:119], v[32:35], v[20:23], v[116:119]
ds_read_b64 v[64:65], v2 offset:9216
ds_read_b64 v[66:67], v2 offset:13824
v_mfma_f32_16x16x32_bf16 v[120:123], v[32:35], v[24:27], v[120:123]
ds_read_b64 v[68:69], v2 offset:9344
v_mfma_f32_16x16x32_bf16 v[124:127], v[32:35], v[28:31], v[124:127]
ds_read_b64 v[70:71], v2 offset:13952
v_mfma_f32_16x16x32_bf16 v[128:131], v[36:39], v[16:19], v[128:131]
ds_read_b64 v[72:73], v11 offset:9472
v_mfma_f32_16x16x32_bf16 v[132:135], v[36:39], v[20:23], v[132:135]
ds_read_b64 v[74:75], v11 offset:14080
v_mfma_f32_16x16x32_bf16 v[136:139], v[36:39], v[24:27], v[136:139]
ds_read_b64 v[76:77], v11 offset:9600
v_mfma_f32_16x16x32_bf16 v[140:143], v[36:39], v[28:31], v[140:143]
ds_read_b64 v[78:79], v11 offset:14208
v_mfma_f32_16x16x32_bf16 v[144:147], v[40:43], v[16:19], v[144:147]
ds_read_b64_tr_b16 v[84:85], v4 offset:14336
v_mfma_f32_16x16x32_bf16 v[148:151], v[40:43], v[20:23], v[148:151]
ds_read_b64_tr_b16 v[86:87], v4 offset:21504
v_mfma_f32_16x16x32_bf16 v[152:155], v[40:43], v[24:27], v[152:155]
ds_read_b64_tr_b16 v[88:89], v5 offset:14336
v_mfma_f32_16x16x32_bf16 v[156:159], v[40:43], v[28:31], v[156:159]
ds_read_b64_tr_b16 v[90:91], v5 offset:21504
v_mfma_f32_16x16x32_bf16 v[160:163], v[44:47], v[16:19], v[160:163]
ds_read_b64_tr_b16 v[92:93], v6 offset:14336
v_mfma_f32_16x16x32_bf16 v[164:167], v[44:47], v[20:23], v[164:167]
ds_read_b64_tr_b16 v[94:95], v6 offset:21504
v_mfma_f32_16x16x32_bf16 v[168:171], v[44:47], v[24:27], v[168:171]
ds_read_b64_tr_b16 v[96:97], v7 offset:14336
v_mfma_f32_16x16x32_bf16 v[172:175], v[44:47], v[28:31], v[172:175]
ds_read_b64_tr_b16 v[98:99], v7 offset:21504
v_mfma_f32_16x16x32_bf16 v[176:179], v[48:51], v[16:19], v[176:179]
ds_read_b64_tr_b16 v[100:101], v8 offset:14336
v_mfma_f32_16x16x32_bf16 v[180:183], v[48:51], v[20:23], v[180:183]
ds_read_b64_tr_b16 v[102:103], v8 offset:21504
v_mfma_f32_16x16x32_bf16 v[184:187], v[48:51], v[24:27], v[184:187]
ds_read_b64_tr_b16 v[104:105], v9 offset:14336
v_mfma_f32_16x16x32_bf16 v[188:191], v[48:51], v[28:31], v[188:191]
ds_read_b64_tr_b16 v[106:107], v9 offset:21504
v_mfma_f32_16x16x32_bf16 v[192:195], v[52:55], v[16:19], v[192:195]
ds_read_b64_tr_b16 v[108:109], v10 offset:14336
v_mfma_f32_16x16x32_bf16 v[196:199], v[52:55], v[20:23], v[196:199]
ds_read_b64_tr_b16 v[110:111], v10 offset:21504
v_mfma_f32_16x16x32_bf16 v[200:203], v[52:55], v[24:27], v[200:203]
v_mfma_f32_16x16x32_bf16 v[204:207], v[52:55], v[28:31], v[204:207]
v_mfma_f32_16x16x32_bf16 v[208:211], v[56:59], v[16:19], v[208:211]
v_mfma_f32_16x16x32_bf16 v[212:215], v[56:59], v[20:23], v[212:215]
s_waitcnt lgkmcnt(0)
s_barrier
v_add_u32 v2, 47104, v2
v_add_u32 v11, 47104, v11
v_mfma_f32_16x16x32_bf16 v[216:219], v[60:63], v[16:19], v[216:219]
v_add_u32 v3, 47104, v3
v_add_u32 v4, 47104, v4
v_mfma_f32_16x16x32_bf16 v[220:223], v[60:63], v[20:23], v[220:223]
v_add_u32 v5, 47104, v5
v_add_u32 v6, 47104, v6
v_add_u32 v7, 47104, v7
v_add_u32 v8, 47104, v8
v_add_u32 v9, 47104, v9
v_add_u32 v10, 47104, v10
v_mfma_f32_16x16x32_bf16 v[112:115], v[80:83], v[64:67], v[112:115]
ds_read_b64_tr_b16 v[32:33], v3 offset:0
v_mfma_f32_16x16x32_bf16 v[116:119], v[80:83], v[68:71], v[116:119]
ds_read_b64_tr_b16 v[34:35], v3 offset:7168
v_mfma_f32_16x16x32_bf16 v[120:123], v[80:83], v[72:75], v[120:123]
ds_read_b64 v[16:17], v2 offset:0
v_mfma_f32_16x16x32_bf16 v[124:127], v[80:83], v[76:79], v[124:127]
ds_read_b64 v[18:19], v2 offset:4608
v_mfma_f32_16x16x32_bf16 v[128:131], v[84:87], v[64:67], v[128:131]
ds_read_b64 v[20:21], v2 offset:128
v_mfma_f32_16x16x32_bf16 v[132:135], v[84:87], v[68:71], v[132:135]
ds_read_b64 v[22:23], v2 offset:4736
v_mfma_f32_16x16x32_bf16 v[136:139], v[84:87], v[72:75], v[136:139]
ds_read_b64 v[24:25], v11 offset:256
v_mfma_f32_16x16x32_bf16 v[140:143], v[84:87], v[76:79], v[140:143]
ds_read_b64 v[26:27], v11 offset:4864
v_mfma_f32_16x16x32_bf16 v[144:147], v[88:91], v[64:67], v[144:147]
ds_read_b64 v[28:29], v11 offset:384
v_mfma_f32_16x16x32_bf16 v[148:151], v[88:91], v[68:71], v[148:151]
ds_read_b64 v[30:31], v11 offset:4992
v_mfma_f32_16x16x32_bf16 v[152:155], v[88:91], v[72:75], v[152:155]
ds_read_b64_tr_b16 v[36:37], v4 offset:0
v_mfma_f32_16x16x32_bf16 v[156:159], v[88:91], v[76:79], v[156:159]
ds_read_b64_tr_b16 v[38:39], v4 offset:7168
v_mfma_f32_16x16x32_bf16 v[160:163], v[92:95], v[64:67], v[160:163]
ds_read_b64_tr_b16 v[40:41], v5 offset:0
v_mfma_f32_16x16x32_bf16 v[164:167], v[92:95], v[68:71], v[164:167]
ds_read_b64_tr_b16 v[42:43], v5 offset:7168
v_mfma_f32_16x16x32_bf16 v[168:171], v[92:95], v[72:75], v[168:171]
ds_read_b64_tr_b16 v[44:45], v6 offset:0
v_mfma_f32_16x16x32_bf16 v[172:175], v[92:95], v[76:79], v[172:175]
ds_read_b64_tr_b16 v[46:47], v6 offset:7168
v_mfma_f32_16x16x32_bf16 v[176:179], v[96:99], v[64:67], v[176:179]
ds_read_b64_tr_b16 v[48:49], v7 offset:0
v_mfma_f32_16x16x32_bf16 v[180:183], v[96:99], v[68:71], v[180:183]
ds_read_b64_tr_b16 v[50:51], v7 offset:7168
v_mfma_f32_16x16x32_bf16 v[184:187], v[96:99], v[72:75], v[184:187]
ds_read_b64_tr_b16 v[52:53], v8 offset:0
v_mfma_f32_16x16x32_bf16 v[188:191], v[96:99], v[76:79], v[188:191]
ds_read_b64_tr_b16 v[54:55], v8 offset:7168
v_mfma_f32_16x16x32_bf16 v[192:195], v[100:103], v[64:67], v[192:195]
ds_read_b64_tr_b16 v[56:57], v9 offset:0
v_mfma_f32_16x16x32_bf16 v[196:199], v[100:103], v[68:71], v[196:199]
ds_read_b64_tr_b16 v[58:59], v9 offset:7168
v_mfma_f32_16x16x32_bf16 v[200:203], v[100:103], v[72:75], v[200:203]
ds_read_b64_tr_b16 v[60:61], v10 offset:0
v_mfma_f32_16x16x32_bf16 v[204:207], v[100:103], v[76:79], v[204:207]
ds_read_b64_tr_b16 v[62:63], v10 offset:7168
v_mfma_f32_16x16x32_bf16 v[208:211], v[104:107], v[64:67], v[208:211]
v_mfma_f32_16x16x32_bf16 v[212:215], v[104:107], v[68:71], v[212:215]
v_mfma_f32_16x16x32_bf16 v[216:219], v[108:111], v[64:67], v[216:219]
v_mfma_f32_16x16x32_bf16 v[220:223], v[108:111], v[68:71], v[220:223]
s_waitcnt lgkmcnt(0)
v_mfma_f32_16x16x32_bf16 v[112:115], v[32:35], v[16:19], v[112:115]
ds_read_b64_tr_b16 v[80:81], v3 offset:14336
ds_read_b64_tr_b16 v[82:83], v3 offset:21504
v_mfma_f32_16x16x32_bf16 v[116:119], v[32:35], v[20:23], v[116:119]
ds_read_b64 v[64:65], v2 offset:9216
ds_read_b64 v[66:67], v2 offset:13824
v_mfma_f32_16x16x32_bf16 v[120:123], v[32:35], v[24:27], v[120:123]
ds_read_b64 v[68:69], v2 offset:9344
v_mfma_f32_16x16x32_bf16 v[124:127], v[32:35], v[28:31], v[124:127]
ds_read_b64 v[70:71], v2 offset:13952
v_mfma_f32_16x16x32_bf16 v[128:131], v[36:39], v[16:19], v[128:131]
ds_read_b64 v[72:73], v11 offset:9472
v_mfma_f32_16x16x32_bf16 v[132:135], v[36:39], v[20:23], v[132:135]
ds_read_b64 v[74:75], v11 offset:14080
v_mfma_f32_16x16x32_bf16 v[136:139], v[36:39], v[24:27], v[136:139]
ds_read_b64 v[76:77], v11 offset:9600
v_mfma_f32_16x16x32_bf16 v[140:143], v[36:39], v[28:31], v[140:143]
ds_read_b64 v[78:79], v11 offset:14208
v_mfma_f32_16x16x32_bf16 v[144:147], v[40:43], v[16:19], v[144:147]
ds_read_b64_tr_b16 v[84:85], v4 offset:14336
v_mfma_f32_16x16x32_bf16 v[148:151], v[40:43], v[20:23], v[148:151]
ds_read_b64_tr_b16 v[86:87], v4 offset:21504
v_mfma_f32_16x16x32_bf16 v[152:155], v[40:43], v[24:27], v[152:155]
ds_read_b64_tr_b16 v[88:89], v5 offset:14336
v_mfma_f32_16x16x32_bf16 v[156:159], v[40:43], v[28:31], v[156:159]
ds_read_b64_tr_b16 v[90:91], v5 offset:21504
v_mfma_f32_16x16x32_bf16 v[160:163], v[44:47], v[16:19], v[160:163]
ds_read_b64_tr_b16 v[92:93], v6 offset:14336
v_mfma_f32_16x16x32_bf16 v[164:167], v[44:47], v[20:23], v[164:167]
ds_read_b64_tr_b16 v[94:95], v6 offset:21504
v_mfma_f32_16x16x32_bf16 v[168:171], v[44:47], v[24:27], v[168:171]
ds_read_b64_tr_b16 v[96:97], v7 offset:14336
v_mfma_f32_16x16x32_bf16 v[172:175], v[44:47], v[28:31], v[172:175]
ds_read_b64_tr_b16 v[98:99], v7 offset:21504
v_mfma_f32_16x16x32_bf16 v[176:179], v[48:51], v[16:19], v[176:179]
ds_read_b64_tr_b16 v[100:101], v8 offset:14336
v_mfma_f32_16x16x32_bf16 v[180:183], v[48:51], v[20:23], v[180:183]
ds_read_b64_tr_b16 v[102:103], v8 offset:21504
v_mfma_f32_16x16x32_bf16 v[184:187], v[48:51], v[24:27], v[184:187]
ds_read_b64_tr_b16 v[104:105], v9 offset:14336
v_mfma_f32_16x16x32_bf16 v[188:191], v[48:51], v[28:31], v[188:191]
ds_read_b64_tr_b16 v[106:107], v9 offset:21504
v_mfma_f32_16x16x32_bf16 v[192:195], v[52:55], v[16:19], v[192:195]
ds_read_b64_tr_b16 v[108:109], v10 offset:14336
v_mfma_f32_16x16x32_bf16 v[196:199], v[52:55], v[20:23], v[196:199]
ds_read_b64_tr_b16 v[110:111], v10 offset:21504
v_mfma_f32_16x16x32_bf16 v[200:203], v[52:55], v[24:27], v[200:203]
v_mfma_f32_16x16x32_bf16 v[204:207], v[52:55], v[28:31], v[204:207]
v_mfma_f32_16x16x32_bf16 v[208:211], v[56:59], v[16:19], v[208:211]
v_mfma_f32_16x16x32_bf16 v[212:215], v[56:59], v[20:23], v[212:215]
s_waitcnt lgkmcnt(0)
s_barrier
v_add_u32 v2, 47104, v2
v_add_u32 v11, 47104, v11
v_mfma_f32_16x16x32_bf16 v[216:219], v[60:63], v[16:19], v[216:219]
v_add_u32 v3, 47104, v3
v_add_u32 v4, 47104, v4
v_mfma_f32_16x16x32_bf16 v[220:223], v[60:63], v[20:23], v[220:223]
v_add_u32 v5, 47104, v5
v_add_u32 v6, 47104, v6
v_add_u32 v7, 47104, v7
v_add_u32 v8, 47104, v8
v_add_u32 v9, 47104, v9
v_add_u32 v10, 47104, v10
v_mfma_f32_16x16x32_bf16 v[112:115], v[80:83], v[64:67], v[112:115]
ds_read_b64_tr_b16 v[32:33], v3 offset:0
v_mfma_f32_16x16x32_bf16 v[116:119], v[80:83], v[68:71], v[116:119]
ds_read_b64_tr_b16 v[34:35], v3 offset:7168
v_mfma_f32_16x16x32_bf16 v[120:123], v[80:83], v[72:75], v[120:123]
ds_read_b64 v[16:17], v2 offset:0
v_mfma_f32_16x16x32_bf16 v[124:127], v[80:83], v[76:79], v[124:127]
ds_read_b64 v[18:19], v2 offset:4608
v_mfma_f32_16x16x32_bf16 v[128:131], v[84:87], v[64:67], v[128:131]
ds_read_b64 v[20:21], v2 offset:128
v_mfma_f32_16x16x32_bf16 v[132:135], v[84:87], v[68:71], v[132:135]
ds_read_b64 v[22:23], v2 offset:4736
v_mfma_f32_16x16x32_bf16 v[136:139], v[84:87], v[72:75], v[136:139]
ds_read_b64 v[24:25], v11 offset:256
v_mfma_f32_16x16x32_bf16 v[140:143], v[84:87], v[76:79], v[140:143]
ds_read_b64 v[26:27], v11 offset:4864
v_mfma_f32_16x16x32_bf16 v[144:147], v[88:91], v[64:67], v[144:147]
ds_read_b64 v[28:29], v11 offset:384
v_mfma_f32_16x16x32_bf16 v[148:151], v[88:91], v[68:71], v[148:151]
ds_read_b64 v[30:31], v11 offset:4992
v_mfma_f32_16x16x32_bf16 v[152:155], v[88:91], v[72:75], v[152:155]
ds_read_b64_tr_b16 v[36:37], v4 offset:0
v_mfma_f32_16x16x32_bf16 v[156:159], v[88:91], v[76:79], v[156:159]
ds_read_b64_tr_b16 v[38:39], v4 offset:7168
v_mfma_f32_16x16x32_bf16 v[160:163], v[92:95], v[64:67], v[160:163]
ds_read_b64_tr_b16 v[40:41], v5 offset:0
v_mfma_f32_16x16x32_bf16 v[164:167], v[92:95], v[68:71], v[164:167]
ds_read_b64_tr_b16 v[42:43], v5 offset:7168
v_mfma_f32_16x16x32_bf16 v[168:171], v[92:95], v[72:75], v[168:171]
ds_read_b64_tr_b16 v[44:45], v6 offset:0
v_mfma_f32_16x16x32_bf16 v[172:175], v[92:95], v[76:79], v[172:175]
ds_read_b64_tr_b16 v[46:47], v6 offset:7168
v_mfma_f32_16x16x32_bf16 v[176:179], v[96:99], v[64:67], v[176:179]
ds_read_b64_tr_b16 v[48:49], v7 offset:0
v_mfma_f32_16x16x32_bf16 v[180:183], v[96:99], v[68:71], v[180:183]
ds_read_b64_tr_b16 v[50:51], v7 offset:7168
v_mfma_f32_16x16x32_bf16 v[184:187], v[96:99], v[72:75], v[184:187]
ds_read_b64_tr_b16 v[52:53], v8 offset:0
v_mfma_f32_16x16x32_bf16 v[188:191], v[96:99], v[76:79], v[188:191]
ds_read_b64_tr_b16 v[54:55], v8 offset:7168
v_mfma_f32_16x16x32_bf16 v[192:195], v[100:103], v[64:67], v[192:195]
ds_read_b64_tr_b16 v[56:57], v9 offset:0
v_mfma_f32_16x16x32_bf16 v[196:199], v[100:103], v[68:71], v[196:199]
ds_read_b64_tr_b16 v[58:59], v9 offset:7168
v_mfma_f32_16x16x32_bf16 v[200:203], v[100:103], v[72:75], v[200:203]
ds_read_b64_tr_b16 v[60:61], v10 offset:0
v_mfma_f32_16x16x32_bf16 v[204:207], v[100:103], v[76:79], v[204:207]
ds_read_b64_tr_b16 v[62:63], v10 offset:7168
v_mfma_f32_16x16x32_bf16 v[208:211], v[104:107], v[64:67], v[208:211]
s_cmp_eq_u32 s49, 1
s_cbranch_scc0 G1A_NOST
buffer_load_dwordx2 v[224:225], v13, s[36:39], s62 offen offset:0 sc1
buffer_load_dwordx2 v[226:227], v13, s[36:39], s62 offen offset:128 sc1
buffer_load_dwordx2 v[228:229], v13, s[36:39], s63 offen offset:0 sc1
buffer_load_dwordx2 v[230:231], v13, s[36:39], s63 offen offset:128 sc1
G1A_NOST:
v_mfma_f32_16x16x32_bf16 v[212:215], v[104:107], v[68:71], v[212:215]
v_mfma_f32_16x16x32_bf16 v[216:219], v[108:111], v[64:67], v[216:219]
v_mfma_f32_16x16x32_bf16 v[220:223], v[108:111], v[68:71], v[220:223]
s_waitcnt lgkmcnt(0)
v_mfma_f32_16x16x32_bf16 v[112:115], v[32:35], v[16:19], v[112:115]
ds_read_b64_tr_b16 v[80:81], v3 offset:14336
ds_read_b64_tr_b16 v[82:83], v3 offset:21504
v_mfma_f32_16x16x32_bf16 v[116:119], v[32:35], v[20:23], v[116:119]
ds_read_b64 v[64:65], v2 offset:9216
ds_read_b64 v[66:67], v2 offset:13824
v_mfma_f32_16x16x32_bf16 v[120:123], v[32:35], v[24:27], v[120:123]
ds_read_b64 v[68:69], v2 offset:9344
v_mfma_f32_16x16x32_bf16 v[124:127], v[32:35], v[28:31], v[124:127]
ds_read_b64 v[70:71], v2 offset:13952
v_mfma_f32_16x16x32_bf16 v[128:131], v[36:39], v[16:19], v[128:131]
ds_read_b64 v[72:73], v11 offset:9472
v_mfma_f32_16x16x32_bf16 v[132:135], v[36:39], v[20:23], v[132:135]
ds_read_b64 v[74:75], v11 offset:14080
v_mfma_f32_16x16x32_bf16 v[136:139], v[36:39], v[24:27], v[136:139]
ds_read_b64 v[76:77], v11 offset:9600
v_mfma_f32_16x16x32_bf16 v[140:143], v[36:39], v[28:31], v[140:143]
ds_read_b64 v[78:79], v11 offset:14208
v_mfma_f32_16x16x32_bf16 v[144:147], v[40:43], v[16:19], v[144:147]
ds_read_b64_tr_b16 v[84:85], v4 offset:14336
v_mfma_f32_16x16x32_bf16 v[148:151], v[40:43], v[20:23], v[148:151]
ds_read_b64_tr_b16 v[86:87], v4 offset:21504
v_mfma_f32_16x16x32_bf16 v[152:155], v[40:43], v[24:27], v[152:155]
ds_read_b64_tr_b16 v[88:89], v5 offset:14336
v_mfma_f32_16x16x32_bf16 v[156:159], v[40:43], v[28:31], v[156:159]
ds_read_b64_tr_b16 v[90:91], v5 offset:21504
v_mfma_f32_16x16x32_bf16 v[160:163], v[44:47], v[16:19], v[160:163]
ds_read_b64_tr_b16 v[92:93], v6 offset:14336
v_mfma_f32_16x16x32_bf16 v[164:167], v[44:47], v[20:23], v[164:167]
ds_read_b64_tr_b16 v[94:95], v6 offset:21504
v_mfma_f32_16x16x32_bf16 v[168:171], v[44:47], v[24:27], v[168:171]
ds_read_b64_tr_b16 v[96:97], v7 offset:14336
v_mfma_f32_16x16x32_bf16 v[172:175], v[44:47], v[28:31], v[172:175]
ds_read_b64_tr_b16 v[98:99], v7 offset:21504
v_mfma_f32_16x16x32_bf16 v[176:179], v[48:51], v[16:19], v[176:179]
ds_read_b64_tr_b16 v[100:101], v8 offset:14336
v_mfma_f32_16x16x32_bf16 v[180:183], v[48:51], v[20:23], v[180:183]
ds_read_b64_tr_b16 v[102:103], v8 offset:21504
v_mfma_f32_16x16x32_bf16 v[184:187], v[48:51], v[24:27], v[184:187]
ds_read_b64_tr_b16 v[104:105], v9 offset:14336
v_mfma_f32_16x16x32_bf16 v[188:191], v[48:51], v[28:31], v[188:191]
ds_read_b64_tr_b16 v[106:107], v9 offset:21504
v_mfma_f32_16x16x32_bf16 v[192:195], v[52:55], v[16:19], v[192:195]
ds_read_b64_tr_b16 v[108:109], v10 offset:14336
v_mfma_f32_16x16x32_bf16 v[196:199], v[52:55], v[20:23], v[196:199]
ds_read_b64_tr_b16 v[110:111], v10 offset:21504
v_mfma_f32_16x16x32_bf16 v[200:203], v[52:55], v[24:27], v[200:203]
v_mfma_f32_16x16x32_bf16 v[204:207], v[52:55], v[28:31], v[204:207]
v_mfma_f32_16x16x32_bf16 v[208:211], v[56:59], v[16:19], v[208:211]
v_mfma_f32_16x16x32_bf16 v[212:215], v[56:59], v[20:23], v[212:215]
s_waitcnt lgkmcnt(0)
s_barrier
v_add_u32 v2, 4294873088, v2
v_add_u32 v11, 4294873088, v11
v_mfma_f32_16x16x32_bf16 v[216:219], v[60:63], v[16:19], v[216:219]
v_add_u32 v3, 4294873088, v3
v_add_u32 v4, 4294873088, v4
v_mfma_f32_16x16x32_bf16 v[220:223], v[60:63], v[20:23], v[220:223]
v_add_u32 v5, 4294873088, v5
v_add_u32 v6, 4294873088, v6
v_add_u32 v7, 4294873088, v7
v_add_u32 v8, 4294873088, v8
v_add_u32 v9, 4294873088, v9
v_add_u32 v10, 4294873088, v10
v_mfma_f32_16x16x32_bf16 v[112:115], v[80:83], v[64:67], v[112:115]
ds_read_b64_tr_b16 v[32:33], v3 offset:0
v_mfma_f32_16x16x32_bf16 v[116:119], v[80:83], v[68:71], v[116:119]
ds_read_b64_tr_b16 v[34:35], v3 offset:7168
v_mfma_f32_16x16x32_bf16 v[120:123], v[80:83], v[72:75], v[120:123]
ds_read_b64 v[16:17], v2 offset:0
v_mfma_f32_16x16x32_bf16 v[124:127], v[80:83], v[76:79], v[124:127]
ds_read_b64 v[18:19], v2 offset:4608
v_mfma_f32_16x16x32_bf16 v[128:131], v[84:87], v[64:67], v[128:131]
ds_read_b64 v[20:21], v2 offset:128
v_mfma_f32_16x16x32_bf16 v[132:135], v[84:87], v[68:71], v[132:135]
ds_read_b64 v[22:23], v2 offset:4736
v_mfma_f32_16x16x32_bf16 v[136:139], v[84:87], v[72:75], v[136:139]
ds_read_b64 v[24:25], v11 offset:256
v_mfma_f32_16x16x32_bf16 v[140:143], v[84:87], v[76:79], v[140:143]
ds_read_b64 v[26:27], v11 offset:4864
v_mfma_f32_16x16x32_bf16 v[144:147], v[88:91], v[64:67], v[144:147]
ds_read_b64 v[28:29], v11 offset:384
v_mfma_f32_16x16x32_bf16 v[148:151], v[88:91], v[68:71], v[148:151]
ds_read_b64 v[30:31], v11 offset:4992
v_mfma_f32_16x16x32_bf16 v[152:155], v[88:91], v[72:75], v[152:155]
ds_read_b64_tr_b16 v[36:37], v4 offset:0
v_mfma_f32_16x16x32_bf16 v[156:159], v[88:91], v[76:79], v[156:159]
ds_read_b64_tr_b16 v[38:39], v4 offset:7168
v_mfma_f32_16x16x32_bf16 v[160:163], v[92:95], v[64:67], v[160:163]
ds_read_b64_tr_b16 v[40:41], v5 offset:0
v_mfma_f32_16x16x32_bf16 v[164:167], v[92:95], v[68:71], v[164:167]
ds_read_b64_tr_b16 v[42:43], v5 offset:7168
v_mfma_f32_16x16x32_bf16 v[168:171], v[92:95], v[72:75], v[168:171]
ds_read_b64_tr_b16 v[44:45], v6 offset:0
v_mfma_f32_16x16x32_bf16 v[172:175], v[92:95], v[76:79], v[172:175]
ds_read_b64_tr_b16 v[46:47], v6 offset:7168
v_mfma_f32_16x16x32_bf16 v[176:179], v[96:99], v[64:67], v[176:179]
ds_read_b64_tr_b16 v[48:49], v7 offset:0
v_mfma_f32_16x16x32_bf16 v[180:183], v[96:99], v[68:71], v[180:183]
ds_read_b64_tr_b16 v[50:51], v7 offset:7168
v_mfma_f32_16x16x32_bf16 v[184:187], v[96:99], v[72:75], v[184:187]
ds_read_b64_tr_b16 v[52:53], v8 offset:0
v_mfma_f32_16x16x32_bf16 v[188:191], v[96:99], v[76:79], v[188:191]
ds_read_b64_tr_b16 v[54:55], v8 offset:7168
v_mfma_f32_16x16x32_bf16 v[192:195], v[100:103], v[64:67], v[192:195]
ds_read_b64_tr_b16 v[56:57], v9 offset:0
v_mfma_f32_16x16x32_bf16 v[196:199], v[100:103], v[68:71], v[196:199]
ds_read_b64_tr_b16 v[58:59], v9 offset:7168
v_mfma_f32_16x16x32_bf16 v[200:203], v[100:103], v[72:75], v[200:203]
ds_read_b64_tr_b16 v[60:61], v10 offset:0
v_mfma_f32_16x16x32_bf16 v[204:207], v[100:103], v[76:79], v[204:207]
ds_read_b64_tr_b16 v[62:63], v10 offset:7168
v_mfma_f32_16x16x32_bf16 v[208:211], v[104:107], v[64:67], v[208:211]
v_mfma_f32_16x16x32_bf16 v[212:215], v[104:107], v[68:71], v[212:215]
v_mfma_f32_16x16x32_bf16 v[216:219], v[108:111], v[64:67], v[216:219]
v_mfma_f32_16x16x32_bf16 v[220:223], v[108:111], v[68:71], v[220:223]
s_waitcnt lgkmcnt(0)
s_sub_u32 s49, s49, 1
s_cmp_lg_u32 s49, 0
s_cbranch_scc1 G1A_LOOP
CODE_G1A_T:
v_mfma_f32_16x16x32_bf16 v[112:115], v[32:35], v[16:19], v[112:115]
ds_read_b64_tr_b16 v[80:81], v3 offset:14336
ds_read_b64_tr_b16 v[82:83], v3 offset:21504
v_mfma_f32_16x16x32_bf16 v[116:119], v[32:35], v[20:23], v[116:119]
ds_read_b64 v[64:65], v2 offset:9216
ds_read_b64 v[66:67], v2 offset:13824
v_mfma_f32_16x16x32_bf16 v[120:123], v[32:35], v[24:27], v[120:123]
ds_read_b64 v[68:69], v2 offset:9344
v_mfma_f32_16x16x32_bf16 v[124:127], v[32:35], v[28:31], v[124:127]
ds_read_b64 v[70:71], v2 offset:13952
v_mfma_f32_16x16x32_bf16 v[128:131], v[36:39], v[16:19], v[128:131]
ds_read_b64 v[72:73], v11 offset:9472
v_mfma_f32_16x16x32_bf16 v[132:135], v[36:39], v[20:23], v[132:135]
ds_read_b64 v[74:75], v11 offset:14080
v_mfma_f32_16x16x32_bf16 v[136:139], v[36:39], v[24:27], v[136:139]
ds_read_b64 v[76:77], v11 offset:9600
v_mfma_f32_16x16x32_bf16 v[140:143], v[36:39], v[28:31], v[140:143]
ds_read_b64 v[78:79], v11 offset:14208
v_mfma_f32_16x16x32_bf16 v[144:147], v[40:43], v[16:19], v[144:147]
ds_read_b64_tr_b16 v[84:85], v4 offset:14336
v_mfma_f32_16x16x32_bf16 v[148:151], v[40:43], v[20:23], v[148:151]
ds_read_b64_tr_b16 v[86:87], v4 offset:21504
v_mfma_f32_16x16x32_bf16 v[152:155], v[40:43], v[24:27], v[152:155]
ds_read_b64_tr_b16 v[88:89], v5 offset:14336
v_mfma_f32_16x16x32_bf16 v[156:159], v[40:43], v[28:31], v[156:159]
ds_read_b64_tr_b16 v[90:91], v5 offset:21504
v_mfma_f32_16x16x32_bf16 v[160:163], v[44:47], v[16:19], v[160:163]
ds_read_b64_tr_b16 v[92:93], v6 offset:14336
v_mfma_f32_16x16x32_bf16 v[164:167], v[44:47], v[20:23], v[164:167]
ds_read_b64_tr_b16 v[94:95], v6 offset:21504
v_mfma_f32_16x16x32_bf16 v[168:171], v[44:47], v[24:27], v[168:171]
ds_read_b64_tr_b16 v[96:97], v7 offset:14336
v_mfma_f32_16x16x32_bf16 v[172:175], v[44:47], v[28:31], v[172:175]
ds_read_b64_tr_b16 v[98:99], v7 offset:21504
v_mfma_f32_16x16x32_bf16 v[176:179], v[48:51], v[16:19], v[176:179]
ds_read_b64_tr_b16 v[100:101], v8 offset:14336
v_mfma_f32_16x16x32_bf16 v[180:183], v[48:51], v[20:23], v[180:183]
ds_read_b64_tr_b16 v[102:103], v8 offset:21504
v_mfma_f32_16x16x32_bf16 v[184:187], v[48:51], v[24:27], v[184:187]
ds_read_b64_tr_b16 v[104:105], v9 offset:14336
v_mfma_f32_16x16x32_bf16 v[188:191], v[48:51], v[28:31], v[188:191]
ds_read_b64_tr_b16 v[106:107], v9 offset:21504
v_mfma_f32_16x16x32_bf16 v[192:195], v[52:55], v[16:19], v[192:195]
ds_read_b64_tr_b16 v[108:109], v10 offset:14336
v_mfma_f32_16x16x32_bf16 v[196:199], v[52:55], v[20:23], v[196:199]
ds_read_b64_tr_b16 v[110:111], v10 offset:21504
v_mfma_f32_16x16x32_bf16 v[200:203], v[52:55], v[24:27], v[200:203]
v_mfma_f32_16x16x32_bf16 v[204:207], v[52:55], v[28:31], v[204:207]
v_mfma_f32_16x16x32_bf16 v[208:211], v[56:59], v[16:19], v[208:211]
v_mfma_f32_16x16x32_bf16 v[212:215], v[56:59], v[20:23], v[212:215]
v_mfma_f32_16x16x32_bf16 v[216:219], v[60:63], v[16:19], v[216:219]
v_mfma_f32_16x16x32_bf16 v[220:223], v[60:63], v[20:23], v[220:223]
s_waitcnt lgkmcnt(0)
v_mfma_f32_16x16x32_bf16 v[112:115], v[80:83], v[64:67], v[112:115]
v_mfma_f32_16x16x32_bf16 v[116:119], v[80:83], v[68:71], v[116:119]
v_mfma_f32_16x16x32_bf16 v[120:123], v[80:83], v[72:75], v[120:123]
v_mfma_f32_16x16x32_bf16 v[124:127], v[80:83], v[76:79], v[124:127]
v_mfma_f32_16x16x32_bf16 v[128:131], v[84:87], v[64:67], v[128:131]
v_mfma_f32_16x16x32_bf16 v[132:135], v[84:87], v[68:71], v[132:135]
v_mfma_f32_16x16x32_bf16 v[136:139], v[84:87], v[72:75], v[136:139]
v_mfma_f32_16x16x32_bf16 v[140:143], v[84:87], v[76:79], v[140:143]
v_mfma_f32_16x16x32_bf16 v[144:147], v[88:91], v[64:67], v[144:147]
v_mfma_f32_16x16x32_bf16 v[148:151], v[88:91], v[68:71], v[148:151]
v_mfma_f32_16x16x32_bf16 v[152:155], v[88:91], v[72:75], v[152:155]
v_mfma_f32_16x16x32_bf16 v[156:159], v[88:91], v[76:79], v[156:159]
v_mfma_f32_16x16x32_bf16 v[160:163], v[92:95], v[64:67], v[160:163]
v_mfma_f32_16x16x32_bf16 v[164:167], v[92:95], v[68:71], v[164:167]
v_mfma_f32_16x16x32_bf16 v[168:171], v[92:95], v[72:75], v[168:171]
v_mfma_f32_16x16x32_bf16 v[172:175], v[92:95], v[76:79], v[172:175]
v_mfma_f32_16x16x32_bf16 v[176:179], v[96:99], v[64:67], v[176:179]
v_mfma_f32_16x16x32_bf16 v[180:183], v[96:99], v[68:71], v[180:183]
v_mfma_f32_16x16x32_bf16 v[184:187], v[96:99], v[72:75], v[184:187]
v_mfma_f32_16x16x32_bf16 v[188:191], v[96:99], v[76:79], v[188:191]
v_mfma_f32_16x16x32_bf16 v[192:195], v[100:103], v[64:67], v[192:195]
v_mfma_f32_16x16x32_bf16 v[196:199], v[100:103], v[68:71], v[196:199]
v_mfma_f32_16x16x32_bf16 v[200:203], v[100:103], v[72:75], v[200:203]
v_mfma_f32_16x16x32_bf16 v[204:207], v[100:103], v[76:79], v[204:207]
v_mfma_f32_16x16x32_bf16 v[208:211], v[104:107], v[64:67], v[208:211]
v_mfma_f32_16x16x32_bf16 v[212:215], v[104:107], v[68:71], v[212:215]
v_mfma_f32_16x16x32_bf16 v[216:219], v[108:111], v[64:67], v[216:219]
v_mfma_f32_16x16x32_bf16 v[220:223], v[108:111], v[68:71], v[220:223]
s_barrier
s_mov_b32 s66, 200000
G1A_SPIN:
s_waitcnt vmcnt(0)
v_cmp_eq_u32 vcc, -1, v224
v_cmp_eq_u32 s[50:51], -1, v226
s_nop 3
s_or_b64 vcc, vcc, s[50:51]
v_cmp_eq_u32 s[50:51], -1, v228
s_nop 3
s_or_b64 vcc, vcc, s[50:51]
v_cmp_eq_u32 s[50:51], -1, v230
s_nop 3
s_or_b64 vcc, vcc, s[50:51]
s_cbranch_vccz G1A_GOT
s_sub_u32 s66, s66, 1
s_cmp_eq_u32 s66, 0
s_cbranch_scc1 G1A_GOT
buffer_load_dwordx2 v[224:225], v13, s[36:39], s62 offen offset:0 sc1
buffer_load_dwordx2 v[226:227], v13, s[36:39], s62 offen offset:128 sc1
buffer_load_dwordx2 v[228:229], v13, s[36:39], s63 offen offset:0 sc1
buffer_load_dwordx2 v[230:231], v13, s[36:39], s63 offen offset:128 sc1
s_branch G1A_SPIN
G1A_GOT:
v_lshrrev_b32 v12, 4, v1
v_lshlrev_b32 v12, 4, v12
v_add_u32 v12, 141312, v12
s_lshl_b32 s66, s84, 6
v_add_u32 v3, s66, v12
s_lshl_b32 s66, s85, 6
v_add_u32 v4, s66, v12
s_lshl_b32 s66, s86, 6
v_add_u32 v5, s66, v12
s_lshl_b32 s66, s87, 6
v_add_u32 v6, s66, v12
s_lshl_b32 s66, s88, 6
v_add_u32 v7, s66, v12
s_lshl_b32 s66, s89, 6
v_add_u32 v8, s66, v12
s_lshl_b32 s66, s90, 6
v_add_u32 v9, s66, v12
s_lshl_b32 s66, s91, 6
v_add_u32 v10, s66, v12
ds_read_b128 v[48:51], v3 offset:3584
ds_read_b128 v[52:55], v4 offset:3584
ds_read_b128 v[56:59], v5 offset:3584
ds_read_b128 v[60:63], v6 offset:3584
ds_read_b128 v[64:67], v7 offset:3584
ds_read_b128 v[68:71], v8 offset:3584
ds_read_b128 v[72:75], v9 offset:3584
ds_read_b128 v[76:79], v10 offset:3584
ds_read_b128 v[16:19], v3
ds_read_b128 v[20:23], v4
ds_read_b128 v[24:27], v5
ds_read_b128 v[28:31], v6
ds_read_b128 v[32:35], v7
ds_read_b128 v[36:39], v8
ds_read_b128 v[40:43], v9
ds_read_b128 v[44:47], v10
v_mov_b32 v10, 0xc0135761
v_mov_b32 v11, 0xbdd2d3e8
v_lshlrev_b32 v14, 4, v1
s_lshl_b32 s64, s45, 3
s_lshl_b32 s65, s47, 2
s_add_u32 s64, s64, s65
s_lshl_b32 s65, s48, 1
s_add_u32 s62, s64, s65
s_sub_u32 s63, s64, s65
s_mul_i32 s65, s46, 7
s_mul_i32 s62, s62, 112
s_add_u32 s62, s62, s65
s_lshl_b32 s62, s62, 10
s_mul_i32 s63, s63, 112
s_add_u32 s63, s63, s65
s_lshl_b32 s63, s63, 10
s_lshr_b32 s66, s84, 1
s_lshl_b32 s40, s66, 10
s_lshr_b32 s66, s86, 1
s_lshl_b32 s41, s66, 10
s_lshr_b32 s66, s88, 1
s_lshl_b32 s42, s66, 10
s_lshr_b32 s66, s90, 1
s_lshl_b32 s43, s66, 10
s_waitcnt lgkmcnt(0)
v_pk_fma_f32 v[80:81], v[16:17], v[224:225], v[48:49] op_sel:[0,1,0] op_sel_hi:[1,1,1] neg_lo:[0,1,0] neg_hi:[0,1,0]
v_pk_fma_f32 v[82:83], v[18:19], v[224:225], v[50:51] op_sel:[0,1,0] op_sel_hi:[1,1,1] neg_lo:[0,1,0] neg_hi:[0,1,0]
v_pk_fma_f32 v[84:85], v[20:21], v[224:225], v[52:53] op_sel:[0,1,0] op_sel_hi:[1,1,1] neg_lo:[0,1,0] neg_hi:[0,1,0]
v_pk_fma_f32 v[86:87], v[22:23], v[224:225], v[54:55] op_sel:[0,1,0] op_sel_hi:[1,1,1] neg_lo:[0,1,0] neg_hi:[0,1,0]
v_pk_fma_f32 v[88:89], v[24:25], v[224:225], v[56:57] op_sel:[0,1,0] op_sel_hi:[1,1,1] neg_lo:[0,1,0] neg_hi:[0,1,0]
v_pk_fma_f32 v[90:91], v[26:27], v[224:225], v[58:59] op_sel:[0,1,0] op_sel_hi:[1,1,1] neg_lo:[0,1,0] neg_hi:[0,1,0]
v_pk_fma_f32 v[92:93], v[28:29], v[224:225], v[60:61] op_sel:[0,1,0] op_sel_hi:[1,1,1] neg_lo:[0,1,0] neg_hi:[0,1,0]
v_pk_fma_f32 v[94:95], v[30:31], v[224:225], v[62:63] op_sel:[0,1,0] op_sel_hi:[1,1,1] neg_lo:[0,1,0] neg_hi:[0,1,0]
v_pk_fma_f32 v[96:97], v[32:33], v[224:225], v[64:65] op_sel:[0,1,0] op_sel_hi:[1,1,1] neg_lo:[0,1,0] neg_hi:[0,1,0]
v_pk_fma_f32 v[98:99], v[34:35], v[224:225], v[66:67] op_sel:[0,1,0] op_sel_hi:[1,1,1] neg_lo:[0,1,0] neg_hi:[0,1,0]
v_pk_fma_f32 v[100:101], v[36:37], v[224:225], v[68:69] op_sel:[0,1,0] op_sel_hi:[1,1,1] neg_lo:[0,1,0] neg_hi:[0,1,0]
v_pk_fma_f32 v[102:103], v[38:39], v[224:225], v[70:71] op_sel:[0,1,0] op_sel_hi:[1,1,1] neg_lo:[0,1,0] neg_hi:[0,1,0]
s_add_u32 s64, s62, s40
s_add_u32 s64, s64, 0
s_add_u32 s65, s62, s41
s_add_u32 s65, s65, 0
s_add_u32 s66, s62, s42
s_add_u32 s66, s66, 0
v_pk_fma_f32 v[80:81], v[112:113], v[224:225], v[80:81] op_sel_hi:[1,0,1]
v_pk_fma_f32 v[82:83], v[114:115], v[224:225], v[82:83] op_sel_hi:[1,0,1]
v_pk_fma_f32 v[84:85], v[128:129], v[224:225], v[84:85] op_sel_hi:[1,0,1]
v_pk_fma_f32 v[86:87], v[130:131], v[224:225], v[86:87] op_sel_hi:[1,0,1]
v_pk_fma_f32 v[88:89], v[144:145], v[224:225], v[88:89] op_sel_hi:[1,0,1]
v_pk_fma_f32 v[90:91], v[146:147], v[224:225], v[90:91] op_sel_hi:[1,0,1]
v_pk_fma_f32 v[92:93], v[160:161], v[224:225], v[92:93] op_sel_hi:[1,0,1]
v_pk_fma_f32 v[94:95], v[162:163], v[224:225], v[94:95] op_sel_hi:[1,0,1]
v_pk_fma_f32 v[96:97], v[176:177], v[224:225], v[96:97] op_sel_hi:[1,0,1]
v_pk_fma_f32 v[98:99], v[178:179], v[224:225], v[98:99] op_sel_hi:[1,0,1]
v_pk_fma_f32 v[100:101], v[192:193], v[224:225], v[100:101] op_sel_hi:[1,0,1]
v_pk_fma_f32 v[102:103], v[194:195], v[224:225], v[102:103] op_sel_hi:[1,0,1]
s_call_b64 s[50:51], G1A_GELU
v_pk_fma_f32 v[80:81], v[16:17], v[226:227], v[48:49] op_sel:[0,1,0] op_sel_hi:[1,1,1] neg_lo:[0,1,0] neg_hi:[0,1,0]
v_pk_fma_f32 v[82:83], v[18:19], v[226:227], v[50:51] op_sel:[0,1,0] op_sel_hi:[1,1,1] neg_lo:[0,1,0] neg_hi:[0,1,0]
v_pk_fma_f32 v[84:85], v[20:21], v[226:227], v[52:53] op_sel:[0,1,0] op_sel_hi:[1,1,1] neg_lo:[0,1,0] neg_hi:[0,1,0]
v_pk_fma_f32 v[86:87], v[22:23], v[226:227], v[54:55] op_sel:[0,1,0] op_sel_hi:[1,1,1] neg_lo:[0,1,0] neg_hi:[0,1,0]
v_pk_fma_f32 v[88:89], v[24:25], v[226:227], v[56:57] op_sel:[0,1,0] op_sel_hi:[1,1,1] neg_lo:[0,1,0] neg_hi:[0,1,0]
v_pk_fma_f32 v[90:91], v[26:27], v[226:227], v[58:59] op_sel:[0,1,0] op_sel_hi:[1,1,1] neg_lo:[0,1,0] neg_hi:[0,1,0]
v_pk_fma_f32 v[92:93], v[28:29], v[226:227], v[60:61] op_sel:[0,1,0] op_sel_hi:[1,1,1] neg_lo:[0,1,0] neg_hi:[0,1,0]
v_pk_fma_f32 v[94:95], v[30:31], v[226:227], v[62:63] op_sel:[0,1,0] op_sel_hi:[1,1,1] neg_lo:[0,1,0] neg_hi:[0,1,0]
v_pk_fma_f32 v[96:97], v[32:33], v[226:227], v[64:65] op_sel:[0,1,0] op_sel_hi:[1,1,1] neg_lo:[0,1,0] neg_hi:[0,1,0]
v_pk_fma_f32 v[98:99], v[34:35], v[226:227], v[66:67] op_sel:[0,1,0] op_sel_hi:[1,1,1] neg_lo:[0,1,0] neg_hi:[0,1,0]
v_pk_fma_f32 v[100:101], v[36:37], v[226:227], v[68:69] op_sel:[0,1,0] op_sel_hi:[1,1,1] neg_lo:[0,1,0] neg_hi:[0,1,0]
v_pk_fma_f32 v[102:103], v[38:39], v[226:227], v[70:71] op_sel:[0,1,0] op_sel_hi:[1,1,1] neg_lo:[0,1,0] neg_hi:[0,1,0]
s_add_u32 s64, s62, s40
s_add_u32 s64, s64, 114688
s_add_u32 s65, s62, s41
s_add_u32 s65, s65, 114688
s_add_u32 s66, s62, s42
s_add_u32 s66, s66, 114688
v_pk_fma_f32 v[80:81], v[116:117], v[226:227], v[80:81] op_sel_hi:[1,0,1]
v_pk_fma_f32 v[82:83], v[118:119], v[226:227], v[82:83] op_sel_hi:[1,0,1]
v_pk_fma_f32 v[84:85], v[132:133], v[226:227], v[84:85] op_sel_hi:[1,0,1]
v_pk_fma_f32 v[86:87], v[134:135], v[226:227], v[86:87] op_sel_hi:[1,0,1]
v_pk_fma_f32 v[88:89], v[148:149], v[226:227], v[88:89] op_sel_hi:[1,0,1]
v_pk_fma_f32 v[90:91], v[150:151], v[226:227], v[90:91] op_sel_hi:[1,0,1]
v_pk_fma_f32 v[92:93], v[164:165], v[226:227], v[92:93] op_sel_hi:[1,0,1]
v_pk_fma_f32 v[94:95], v[166:167], v[226:227], v[94:95] op_sel_hi:[1,0,1]
v_pk_fma_f32 v[96:97], v[180:181], v[226:227], v[96:97] op_sel_hi:[1,0,1]
v_pk_fma_f32 v[98:99], v[182:183], v[226:227], v[98:99] op_sel_hi:[1,0,1]
v_pk_fma_f32 v[100:101], v[196:197], v[226:227], v[100:101] op_sel_hi:[1,0,1]
v_pk_fma_f32 v[102:103], v[198:199], v[226:227], v[102:103] op_sel_hi:[1,0,1]
s_call_b64 s[50:51], G1A_GELU
v_pk_fma_f32 v[80:81], v[16:17], v[228:229], v[48:49] op_sel:[0,1,0] op_sel_hi:[1,1,1] neg_lo:[0,1,0] neg_hi:[0,1,0]
v_pk_fma_f32 v[82:83], v[18:19], v[228:229], v[50:51] op_sel:[0,1,0] op_sel_hi:[1,1,1] neg_lo:[0,1,0] neg_hi:[0,1,0]
v_pk_fma_f32 v[84:85], v[20:21], v[228:229], v[52:53] op_sel:[0,1,0] op_sel_hi:[1,1,1] neg_lo:[0,1,0] neg_hi:[0,1,0]
v_pk_fma_f32 v[86:87], v[22:23], v[228:229], v[54:55] op_sel:[0,1,0] op_sel_hi:[1,1,1] neg_lo:[0,1,0] neg_hi:[0,1,0]
v_pk_fma_f32 v[88:89], v[24:25], v[228:229], v[56:57] op_sel:[0,1,0] op_sel_hi:[1,1,1] neg_lo:[0,1,0] neg_hi:[0,1,0]
v_pk_fma_f32 v[90:91], v[26:27], v[228:229], v[58:59] op_sel:[0,1,0] op_sel_hi:[1,1,1] neg_lo:[0,1,0] neg_hi:[0,1,0]
v_pk_fma_f32 v[92:93], v[28:29], v[228:229], v[60:61] op_sel:[0,1,0] op_sel_hi:[1,1,1] neg_lo:[0,1,0] neg_hi:[0,1,0]
v_pk_fma_f32 v[94:95], v[30:31], v[228:229], v[62:63] op_sel:[0,1,0] op_sel_hi:[1,1,1] neg_lo:[0,1,0] neg_hi:[0,1,0]
v_pk_fma_f32 v[96:97], v[32:33], v[228:229], v[64:65] op_sel:[0,1,0] op_sel_hi:[1,1,1] neg_lo:[0,1,0] neg_hi:[0,1,0]
v_pk_fma_f32 v[98:99], v[34:35], v[228:229], v[66:67] op_sel:[0,1,0] op_sel_hi:[1,1,1] neg_lo:[0,1,0] neg_hi:[0,1,0]
v_pk_fma_f32 v[100:101], v[36:37], v[228:229], v[68:69] op_sel:[0,1,0] op_sel_hi:[1,1,1] neg_lo:[0,1,0] neg_hi:[0,1,0]
v_pk_fma_f32 v[102:103], v[38:39], v[228:229], v[70:71] op_sel:[0,1,0] op_sel_hi:[1,1,1] neg_lo:[0,1,0] neg_hi:[0,1,0]
s_add_u32 s64, s63, s40
s_add_u32 s64, s64, 229376
s_add_u32 s65, s63, s41
s_add_u32 s65, s65, 229376
s_add_u32 s66, s63, s42
s_add_u32 s66, s66, 229376
v_pk_fma_f32 v[80:81], v[120:121], v[228:229], v[80:81] op_sel_hi:[1,0,1]
v_pk_fma_f32 v[82:83], v[122:123], v[228:229], v[82:83] op_sel_hi:[1,0,1]
v_pk_fma_f32 v[84:85], v[136:137], v[228:229], v[84:85] op_sel_hi:[1,0,1]
v_pk_fma_f32 v[86:87], v[138:139], v[228:229], v[86:87] op_sel_hi:[1,0,1]
v_pk_fma_f32 v[88:89], v[152:153], v[228:229], v[88:89] op_sel_hi:[1,0,1]
v_pk_fma_f32 v[90:91], v[154:155], v[228:229], v[90:91] op_sel_hi:[1,0,1]
v_pk_fma_f32 v[92:93], v[168:169], v[228:229], v[92:93] op_sel_hi:[1,0,1]
v_pk_fma_f32 v[94:95], v[170:171], v[228:229], v[94:95] op_sel_hi:[1,0,1]
v_pk_fma_f32 v[96:97], v[184:185], v[228:229], v[96:97] op_sel_hi:[1,0,1]
v_pk_fma_f32 v[98:99], v[186:187], v[228:229], v[98:99] op_sel_hi:[1,0,1]
v_pk_fma_f32 v[100:101], v[200:201], v[228:229], v[100:101] op_sel_hi:[1,0,1]
v_pk_fma_f32 v[102:103], v[202:203], v[228:229], v[102:103] op_sel_hi:[1,0,1]
s_call_b64 s[50:51], G1A_GELU
v_pk_fma_f32 v[80:81], v[16:17], v[230:231], v[48:49] op_sel:[0,1,0] op_sel_hi:[1,1,1] neg_lo:[0,1,0] neg_hi:[0,1,0]
v_pk_fma_f32 v[82:83], v[18:19], v[230:231], v[50:51] op_sel:[0,1,0] op_sel_hi:[1,1,1] neg_lo:[0,1,0] neg_hi:[0,1,0]
v_pk_fma_f32 v[84:85], v[20:21], v[230:231], v[52:53] op_sel:[0,1,0] op_sel_hi:[1,1,1] neg_lo:[0,1,0] neg_hi:[0,1,0]
v_pk_fma_f32 v[86:87], v[22:23], v[230:231], v[54:55] op_sel:[0,1,0] op_sel_hi:[1,1,1] neg_lo:[0,1,0] neg_hi:[0,1,0]
v_pk_fma_f32 v[88:89], v[24:25], v[230:231], v[56:57] op_sel:[0,1,0] op_sel_hi:[1,1,1] neg_lo:[0,1,0] neg_hi:[0,1,0]
v_pk_fma_f32 v[90:91], v[26:27], v[230:231], v[58:59] op_sel:[0,1,0] op_sel_hi:[1,1,1] neg_lo:[0,1,0] neg_hi:[0,1,0]
v_pk_fma_f32 v[92:93], v[28:29], v[230:231], v[60:61] op_sel:[0,1,0] op_sel_hi:[1,1,1] neg_lo:[0,1,0] neg_hi:[0,1,0]
v_pk_fma_f32 v[94:95], v[30:31], v[230:231], v[62:63] op_sel:[0,1,0] op_sel_hi:[1,1,1] neg_lo:[0,1,0] neg_hi:[0,1,0]
v_pk_fma_f32 v[96:97], v[32:33], v[230:231], v[64:65] op_sel:[0,1,0] op_sel_hi:[1,1,1] neg_lo:[0,1,0] neg_hi:[0,1,0]
v_pk_fma_f32 v[98:99], v[34:35], v[230:231], v[66:67] op_sel:[0,1,0] op_sel_hi:[1,1,1] neg_lo:[0,1,0] neg_hi:[0,1,0]
v_pk_fma_f32 v[100:101], v[36:37], v[230:231], v[68:69] op_sel:[0,1,0] op_sel_hi:[1,1,1] neg_lo:[0,1,0] neg_hi:[0,1,0]
v_pk_fma_f32 v[102:103], v[38:39], v[230:231], v[70:71] op_sel:[0,1,0] op_sel_hi:[1,1,1] neg_lo:[0,1,0] neg_hi:[0,1,0]
s_add_u32 s64, s63, s40
s_add_u32 s64, s64, 344064
s_add_u32 s65, s63, s41
s_add_u32 s65, s65, 344064
s_add_u32 s66, s63, s42
s_add_u32 s66, s66, 344064
v_pk_fma_f32 v[80:81], v[124:125], v[230:231], v[80:81] op_sel_hi:[1,0,1]
v_pk_fma_f32 v[82:83], v[126:127], v[230:231], v[82:83] op_sel_hi:[1,0,1]
v_pk_fma_f32 v[84:85], v[140:141], v[230:231], v[84:85] op_sel_hi:[1,0,1]
v_pk_fma_f32 v[86:87], v[142:143], v[230:231], v[86:87] op_sel_hi:[1,0,1]
v_pk_fma_f32 v[88:89], v[156:157], v[230:231], v[88:89] op_sel_hi:[1,0,1]
v_pk_fma_f32 v[90:91], v[158:159], v[230:231], v[90:91] op_sel_hi:[1,0,1]
v_pk_fma_f32 v[92:93], v[172:173], v[230:231], v[92:93] op_sel_hi:[1,0,1]
v_pk_fma_f32 v[94:95], v[174:175], v[230:231], v[94:95] op_sel_hi:[1,0,1]
v_pk_fma_f32 v[96:97], v[188:189], v[230:231], v[96:97] op_sel_hi:[1,0,1]
v_pk_fma_f32 v[98:99], v[190:191], v[230:231], v[98:99] op_sel_hi:[1,0,1]
v_pk_fma_f32 v[100:101], v[204:205], v[230:231], v[100:101] op_sel_hi:[1,0,1]
v_pk_fma_f32 v[102:103], v[206:207], v[230:231], v[102:103] op_sel_hi:[1,0,1]
s_call_b64 s[50:51], G1A_GELU
v_pk_fma_f32 v[80:81], v[40:41], v[224:225], v[72:73] op_sel:[0,1,0] op_sel_hi:[1,1,1] neg_lo:[0,1,0] neg_hi:[0,1,0]
v_pk_fma_f32 v[82:83], v[42:43], v[224:225], v[74:75] op_sel:[0,1,0] op_sel_hi:[1,1,1] neg_lo:[0,1,0] neg_hi:[0,1,0]
v_pk_fma_f32 v[84:85], v[44:45], v[224:225], v[76:77] op_sel:[0,1,0] op_sel_hi:[1,1,1] neg_lo:[0,1,0] neg_hi:[0,1,0]
v_pk_fma_f32 v[86:87], v[46:47], v[224:225], v[78:79] op_sel:[0,1,0] op_sel_hi:[1,1,1] neg_lo:[0,1,0] neg_hi:[0,1,0]
s_add_u32 s64, s62, s43
s_add_u32 s64, s64, 0
v_pk_fma_f32 v[80:81], v[208:209], v[224:225], v[80:81] op_sel_hi:[1,0,1]
v_pk_fma_f32 v[82:83], v[210:211], v[224:225], v[82:83] op_sel_hi:[1,0,1]
v_pk_fma_f32 v[84:85], v[216:217], v[224:225], v[84:85] op_sel_hi:[1,0,1]
v_pk_fma_f32 v[86:87], v[218:219], v[224:225], v[86:87] op_sel_hi:[1,0,1]
s_call_b64 s[50:51], G1A_GELU1
v_pk_fma_f32 v[80:81], v[40:41], v[226:227], v[72:73] op_sel:[0,1,0] op_sel_hi:[1,1,1] neg_lo:[0,1,0] neg_hi:[0,1,0]
v_pk_fma_f32 v[82:83], v[42:43], v[226:227], v[74:75] op_sel:[0,1,0] op_sel_hi:[1,1,1] neg_lo:[0,1,0] neg_hi:[0,1,0]
v_pk_fma_f32 v[84:85], v[44:45], v[226:227], v[76:77] op_sel:[0,1,0] op_sel_hi:[1,1,1] neg_lo:[0,1,0] neg_hi:[0,1,0]
v_pk_fma_f32 v[86:87], v[46:47], v[226:227], v[78:79] op_sel:[0,1,0] op_sel_hi:[1,1,1] neg_lo:[0,1,0] neg_hi:[0,1,0]
s_add_u32 s64, s62, s43
s_add_u32 s64, s64, 114688
v_pk_fma_f32 v[80:81], v[212:213], v[226:227], v[80:81] op_sel_hi:[1,0,1]
v_pk_fma_f32 v[82:83], v[214:215], v[226:227], v[82:83] op_sel_hi:[1,0,1]
v_pk_fma_f32 v[84:85], v[220:221], v[226:227], v[84:85] op_sel_hi:[1,0,1]
v_pk_fma_f32 v[86:87], v[222:223], v[226:227], v[86:87] op_sel_hi:[1,0,1]
s_call_b64 s[50:51], G1A_GELU1
s_branch G1A_FIN
G1A_GELU:
v_pk_mul_f32 v[104:105], v[80:81], v[80:81]
v_pk_mul_f32 v[106:107], v[82:83], v[82:83]
v_pk_mul_f32 v[108:109], v[84:85], v[84:85]
v_pk_mul_f32 v[110:111], v[86:87], v[86:87]
v_pk_fma_f32 v[104:105], v[104:105], v[10:11], v[10:11] op_sel:[0,1,0] op_sel_hi:[1,1,0]
v_pk_fma_f32 v[106:107], v[106:107], v[10:11], v[10:11] op_sel:[0,1,0] op_sel_hi:[1,1,0]
v_pk_fma_f32 v[108:109], v[108:109], v[10:11], v[10:11] op_sel:[0,1,0] op_sel_hi:[1,1,0]
v_pk_fma_f32 v[110:111], v[110:111], v[10:11], v[10:11] op_sel:[0,1,0] op_sel_hi:[1,1,0]
v_pk_mul_f32 v[104:105], v[104:105], v[80:81]
v_pk_mul_f32 v[106:107], v[106:107], v[82:83]
v_pk_mul_f32 v[108:109], v[108:109], v[84:85]
v_pk_mul_f32 v[110:111], v[110:111], v[86:87]
v_exp_f32 v2, v104
v_exp_f32 v4, v106
v_exp_f32 v6, v108
v_exp_f32 v8, v110
v_exp_f32 v3, v105
v_exp_f32 v5, v107
v_exp_f32 v7, v109
v_exp_f32 v9, v111
v_pk_add_f32 v[2:3], v[2:3], 1.0 op_sel_hi:[1,0]
v_pk_add_f32 v[4:5], v[4:5], 1.0 op_sel_hi:[1,0]
v_pk_add_f32 v[6:7], v[6:7], 1.0 op_sel_hi:[1,0]
v_pk_add_f32 v[8:9], v[8:9], 1.0 op_sel_hi:[1,0]
v_rcp_f32 v2, v2
v_rcp_f32 v4, v4
v_rcp_f32 v6, v6
v_rcp_f32 v8, v8
v_rcp_f32 v3, v3
v_rcp_f32 v5, v5
v_rcp_f32 v7, v7
v_rcp_f32 v9, v9
v_pk_mul_f32 v[80:81], v[80:81], v[2:3]
v_pk_mul_f32 v[82:83], v[82:83], v[4:5]
v_pk_mul_f32 v[84:85], v[84:85], v[6:7]
v_pk_mul_f32 v[86:87], v[86:87], v[8:9]
v_cvt_pk_bf16_f32 v232, v80, v81
v_cvt_pk_bf16_f32 v233, v82, v83
v_cvt_pk_bf16_f32 v234, v84, v85
v_cvt_pk_bf16_f32 v235, v86, v87
buffer_store_dwordx4 v[232:235], v14, s[32:35], s64 offen sc1
v_pk_mul_f32 v[104:105], v[88:89], v[88:89]
v_pk_mul_f32 v[106:107], v[90:91], v[90:91]
v_pk_mul_f32 v[108:109], v[92:93], v[92:93]
v_pk_mul_f32 v[110:111], v[94:95], v[94:95]
v_pk_fma_f32 v[104:105], v[104:105], v[10:11], v[10:11] op_sel:[0,1,0] op_sel_hi:[1,1,0]
v_pk_fma_f32 v[106:107], v[106:107], v[10:11], v[10:11] op_sel:[0,1,0] op_sel_hi:[1,1,0]
v_pk_fma_f32 v[108:109], v[108:109], v[10:11], v[10:11] op_sel:[0,1,0] op_sel_hi:[1,1,0]
v_pk_fma_f32 v[110:111], v[110:111], v[10:11], v[10:11] op_sel:[0,1,0] op_sel_hi:[1,1,0]
v_pk_mul_f32 v[104:105], v[104:105], v[88:89]
v_pk_mul_f32 v[106:107], v[106:107], v[90:91]
v_pk_mul_f32 v[108:109], v[108:109], v[92:93]
v_pk_mul_f32 v[110:111], v[110:111], v[94:95]
v_exp_f32 v2, v104
v_exp_f32 v4, v106
v_exp_f32 v6, v108
v_exp_f32 v8, v110
v_exp_f32 v3, v105
v_exp_f32 v5, v107
v_exp_f32 v7, v109
v_exp_f32 v9, v111
v_pk_add_f32 v[2:3], v[2:3], 1.0 op_sel_hi:[1,0]
v_pk_add_f32 v[4:5], v[4:5], 1.0 op_sel_hi:[1,0]
v_pk_add_f32 v[6:7], v[6:7], 1.0 op_sel_hi:[1,0]
v_pk_add_f32 v[8:9], v[8:9], 1.0 op_sel_hi:[1,0]
v_rcp_f32 v2, v2
v_rcp_f32 v4, v4
v_rcp_f32 v6, v6
v_rcp_f32 v8, v8
v_rcp_f32 v3, v3
v_rcp_f32 v5, v5
v_rcp_f32 v7, v7
v_rcp_f32 v9, v9
v_pk_mul_f32 v[88:89], v[88:89], v[2:3]
v_pk_mul_f32 v[90:91], v[90:91], v[4:5]
v_pk_mul_f32 v[92:93], v[92:93], v[6:7]
v_pk_mul_f32 v[94:95], v[94:95], v[8:9]
v_cvt_pk_bf16_f32 v236, v88, v89
v_cvt_pk_bf16_f32 v237, v90, v91
v_cvt_pk_bf16_f32 v238, v92, v93
v_cvt_pk_bf16_f32 v239, v94, v95
buffer_store_dwordx4 v[236:239], v14, s[32:35], s65 offen sc1
v_pk_mul_f32 v[104:105], v[96:97], v[96:97]
v_pk_mul_f32 v[106:107], v[98:99], v[98:99]
v_pk_mul_f32 v[108:109], v[100:101], v[100:101]
v_pk_mul_f32 v[110:111], v[102:103], v[102:103]
v_pk_fma_f32 v[104:105], v[104:105], v[10:11], v[10:11] op_sel:[0,1,0] op_sel_hi:[1,1,0]
v_pk_fma_f32 v[106:107], v[106:107], v[10:11], v[10:11] op_sel:[0,1,0] op_sel_hi:[1,1,0]
v_pk_fma_f32 v[108:109], v[108:109], v[10:11], v[10:11] op_sel:[0,1,0] op_sel_hi:[1,1,0]
v_pk_fma_f32 v[110:111], v[110:111], v[10:11], v[10:11] op_sel:[0,1,0] op_sel_hi:[1,1,0]
v_pk_mul_f32 v[104:105], v[104:105], v[96:97]
v_pk_mul_f32 v[106:107], v[106:107], v[98:99]
v_pk_mul_f32 v[108:109], v[108:109], v[100:101]
v_pk_mul_f32 v[110:111], v[110:111], v[102:103]
v_exp_f32 v2, v104
v_exp_f32 v4, v106
v_exp_f32 v6, v108
v_exp_f32 v8, v110
v_exp_f32 v3, v105
v_exp_f32 v5, v107
v_exp_f32 v7, v109
v_exp_f32 v9, v111
v_pk_add_f32 v[2:3], v[2:3], 1.0 op_sel_hi:[1,0]
v_pk_add_f32 v[4:5], v[4:5], 1.0 op_sel_hi:[1,0]
v_pk_add_f32 v[6:7], v[6:7], 1.0 op_sel_hi:[1,0]
v_pk_add_f32 v[8:9], v[8:9], 1.0 op_sel_hi:[1,0]
v_rcp_f32 v2, v2
v_rcp_f32 v4, v4
v_rcp_f32 v6, v6
v_rcp_f32 v8, v8
v_rcp_f32 v3, v3
v_rcp_f32 v5, v5
v_rcp_f32 v7, v7
v_rcp_f32 v9, v9
v_pk_mul_f32 v[96:97], v[96:97], v[2:3]
v_pk_mul_f32 v[98:99], v[98:99], v[4:5]
v_pk_mul_f32 v[100:101], v[100:101], v[6:7]
v_pk_mul_f32 v[102:103], v[102:103], v[8:9]
v_cvt_pk_bf16_f32 v232, v96, v97
v_cvt_pk_bf16_f32 v233, v98, v99
v_cvt_pk_bf16_f32 v234, v100, v101
v_cvt_pk_bf16_f32 v235, v102, v103
buffer_store_dwordx4 v[232:235], v14, s[32:35], s66 offen sc1
s_setpc_b64 s[50:51]
G1A_GELU1:
v_pk_mul_f32 v[104:105], v[80:81], v[80:81]
v_pk_mul_f32 v[106:107], v[82:83], v[82:83]
v_pk_mul_f32 v[108:109], v[84:85], v[84:85]
v_pk_mul_f32 v[110:111], v[86:87], v[86:87]
v_pk_fma_f32 v[104:105], v[104:105], v[10:11], v[10:11] op_sel:[0,1,0] op_sel_hi:[1,1,0]
v_pk_fma_f32 v[106:107], v[106:107], v[10:11], v[10:11] op_sel:[0,1,0] op_sel_hi:[1,1,0]
v_pk_fma_f32 v[108:109], v[108:109], v[10:11], v[10:11] op_sel:[0,1,0] op_sel_hi:[1,1,0]
v_pk_fma_f32 v[110:111], v[110:111], v[10:11], v[10:11] op_sel:[0,1,0] op_sel_hi:[1,1,0]
v_pk_mul_f32 v[104:105], v[104:105], v[80:81]
v_pk_mul_f32 v[106:107], v[106:107], v[82:83]
v_pk_mul_f32 v[108:109], v[108:109], v[84:85]
v_pk_mul_f32 v[110:111], v[110:111], v[86:87]
v_exp_f32 v2, v104
v_exp_f32 v4, v106
v_exp_f32 v6, v108
v_exp_f32 v8, v110
v_exp_f32 v3, v105
v_exp_f32 v5, v107
v_exp_f32 v7, v109
v_exp_f32 v9, v111
v_pk_add_f32 v[2:3], v[2:3], 1.0 op_sel_hi:[1,0]
v_pk_add_f32 v[4:5], v[4:5], 1.0 op_sel_hi:[1,0]
v_pk_add_f32 v[6:7], v[6:7], 1.0 op_sel_hi:[1,0]
v_pk_add_f32 v[8:9], v[8:9], 1.0 op_sel_hi:[1,0]
v_rcp_f32 v2, v2
v_rcp_f32 v4, v4
v_rcp_f32 v6, v6
v_rcp_f32 v8, v8
v_rcp_f32 v3, v3
v_rcp_f32 v5, v5
v_rcp_f32 v7, v7
v_rcp_f32 v9, v9
v_pk_mul_f32 v[80:81], v[80:81], v[2:3]
v_pk_mul_f32 v[82:83], v[82:83], v[4:5]
v_pk_mul_f32 v[84:85], v[84:85], v[6:7]
v_pk_mul_f32 v[86:87], v[86:87], v[8:9]
v_cvt_pk_bf16_f32 v232, v80, v81
v_cvt_pk_bf16_f32 v233, v82, v83
v_cvt_pk_bf16_f32 v234, v84, v85
v_cvt_pk_bf16_f32 v235, v86, v87
buffer_store_dwordx4 v[232:235], v14, s[32:35], s64 offen sc1
s_setpc_b64 s[50:51]
G1A_FIN:
s_branch P2_DONE
CODE_G1A_E:
G1_DMA:
s_setprio 2
s_sub_u32 s50, s44, 4
v_lshlrev_b32 v2, 4, v1
s_mul_i32 s61, s50, 7
s_mul_i32 s56, s50, 4608
s_lshl_b32 s57, s61, 10
s_add_u32 s57, s57, 18432
s_lshl_b32 s51, s50, 16
s_lshl_b32 s64, s45, 10
s_add_u32 s51, s51, s64
s_mul_i32 s52, s46, 448
s_lshl_b32 s64, s61, 6
v_add_u32 v16, s64, v1
v_mul_u32_u24 v17, 2341, v16
v_lshrrev_b32 v17, 16, v17
v_mul_u32_u24 v18, 28, v17
v_sub_u32 v18, v16, v18
s_mov_b32 s63, 7168
v_bfe_u32 v19, v17, 2, 1
v_lshlrev_b32 v19, 1, v19
v_xor_b32 v19, v18, v19
v_lshlrev_b32 v19, 4, v19
v_mad_u32_u24 v3, v17, s63, v19
s_waitcnt lgkmcnt(0)
s_add_u32 s16, s12, 0x1000000
s_addc_u32 s17, s13, 0
s_mov_b32 s18, 0x400000
s_mov_b32 s19, 0x20000
s_mov_b32 s20, s4
s_mov_b32 s21, s5
s_mov_b32 s22, 0x700000
s_mov_b32 s23, 0x20000
s_add_u32 m0, s56, 0
s_add_u32 s54, s51, 0
buffer_load_dwordx4 v2, s[16:19], s54 offen lds
s_add_u32 m0, s56, 1152
s_add_u32 s54, s51, 16384
buffer_load_dwordx4 v2, s[16:19], s54 offen lds
s_add_u32 m0, s56, 2304
s_add_u32 s54, s51, 32768
buffer_load_dwordx4 v2, s[16:19], s54 offen lds
s_add_u32 m0, s56, 3456
s_add_u32 s54, s51, 49152
buffer_load_dwordx4 v2, s[16:19], s54 offen lds
s_add_u32 m0, s57, 0
s_nop 0
buffer_load_dwordx4 v3, s[20:23], s52 offen lds
v_add_u32 v18, 8, v18
v_add_u32 v17, 2, v17
v_cmp_le_u32 vcc, 28, v18
v_subrev_u32 v19, 28, v18
s_nop 0
v_cndmask_b32 v18, v18, v19, vcc
v_addc_co_u32 v17, vcc, 0, v17, vcc
v_bfe_u32 v19, v17, 2, 1
v_lshlrev_b32 v19, 1, v19
v_xor_b32 v19, v18, v19
v_lshlrev_b32 v19, 4, v19
v_mad_u32_u24 v4, v17, s63, v19
s_add_u32 m0, s57, 1024
s_nop 0
buffer_load_dwordx4 v4, s[20:23], s52 offen lds
v_add_u32 v18, 8, v18
v_add_u32 v17, 2, v17
v_cmp_le_u32 vcc, 28, v18
v_subrev_u32 v19, 28, v18
s_nop 0
v_cndmask_b32 v18, v18, v19, vcc
v_addc_co_u32 v17, vcc, 0, v17, vcc
v_bfe_u32 v19, v17, 2, 1
v_lshlrev_b32 v19, 1, v19
v_xor_b32 v19, v18, v19
v_lshlrev_b32 v19, 4, v19
v_mad_u32_u24 v5, v17, s63, v19
s_add_u32 m0, s57, 2048
s_nop 0
buffer_load_dwordx4 v5, s[20:23], s52 offen lds
v_add_u32 v18, 8, v18
v_add_u32 v17, 2, v17
v_cmp_le_u32 vcc, 28, v18
v_subrev_u32 v19, 28, v18
s_nop 0
v_cndmask_b32 v18, v18, v19, vcc
v_addc_co_u32 v17, vcc, 0, v17, vcc
v_bfe_u32 v19, v17, 2, 1
v_lshlrev_b32 v19, 1, v19
v_xor_b32 v19, v18, v19
v_lshlrev_b32 v19, 4, v19
v_mad_u32_u24 v6, v17, s63, v19
s_add_u32 m0, s57, 3072
s_nop 0
buffer_load_dwordx4 v6, s[20:23], s52 offen lds
v_add_u32 v18, 8, v18
v_add_u32 v17, 2, v17
v_cmp_le_u32 vcc, 28, v18
v_subrev_u32 v19, 28, v18
s_nop 0
v_cndmask_b32 v18, v18, v19, vcc
v_addc_co_u32 v17, vcc, 0, v17, vcc
v_bfe_u32 v19, v17, 2, 1
v_lshlrev_b32 v19, 1, v19
v_xor_b32 v19, v18, v19
v_lshlrev_b32 v19, 4, v19
v_mad_u32_u24 v7, v17, s63, v19
s_add_u32 m0, s57, 4096
s_nop 0
buffer_load_dwordx4 v7, s[20:23], s52 offen lds
v_add_u32 v18, 8, v18
v_add_u32 v17, 2, v17
v_cmp_le_u32 vcc, 28, v18
v_subrev_u32 v19, 28, v18
s_nop 0
v_cndmask_b32 v18, v18, v19, vcc
v_addc_co_u32 v17, vcc, 0, v17, vcc
v_bfe_u32 v19, v17, 2, 1
v_lshlrev_b32 v19, 1, v19
v_xor_b32 v19, v18, v19
v_lshlrev_b32 v19, 4, v19
v_mad_u32_u24 v8, v17, s63, v19
s_add_u32 m0, s57, 5120
s_nop 0
buffer_load_dwordx4 v8, s[20:23], s52 offen lds
v_add_u32 v18, 8, v18
v_add_u32 v17, 2, v17
v_cmp_le_u32 vcc, 28, v18
v_subrev_u32 v19, 28, v18
s_nop 0
v_cndmask_b32 v18, v18, v19, vcc
v_addc_co_u32 v17, vcc, 0, v17, vcc
v_bfe_u32 v19, v17, 2, 1
v_lshlrev_b32 v19, 1, v19
v_xor_b32 v19, v18, v19
v_lshlrev_b32 v19, 4, v19
v_mad_u32_u24 v9, v17, s63, v19
s_add_u32 m0, s57, 6144
s_nop 0
buffer_load_dwordx4 v9, s[20:23], s52 offen lds
s_add_u32 s51, s51, 262144
s_add_u32 s52, s52, 458752
s_add_u32 m0, s56, 47104
s_add_u32 s54, s51, 0
buffer_load_dwordx4 v2, s[16:19], s54 offen lds
s_add_u32 m0, s56, 48256
s_add_u32 s54, s51, 16384
buffer_load_dwordx4 v2, s[16:19], s54 offen lds
s_add_u32 m0, s56, 49408
s_add_u32 s54, s51, 32768
buffer_load_dwordx4 v2, s[16:19], s54 offen lds
s_add_u32 m0, s56, 50560
s_add_u32 s54, s51, 49152
buffer_load_dwordx4 v2, s[16:19], s54 offen lds
s_add_u32 m0, s57, 47104
s_nop 0
buffer_load_dwordx4 v3, s[20:23], s52 offen lds
s_add_u32 m0, s57, 48128
s_nop 0
buffer_load_dwordx4 v4, s[20:23], s52 offen lds
s_add_u32 m0, s57, 49152
s_nop 0
buffer_load_dwordx4 v5, s[20:23], s52 offen lds
s_add_u32 m0, s57, 50176
s_nop 0
buffer_load_dwordx4 v6, s[20:23], s52 offen lds
s_add_u32 m0, s57, 51200
s_nop 0
buffer_load_dwordx4 v7, s[20:23], s52 offen lds
s_add_u32 m0, s57, 52224
s_nop 0
buffer_load_dwordx4 v8, s[20:23], s52 offen lds
s_add_u32 m0, s57, 53248
s_nop 0
buffer_load_dwordx4 v9, s[20:23], s52 offen lds
s_add_u32 s51, s51, 262144
s_add_u32 s52, s52, 458752
s_add_u32 s24, s12, 0x1410000
s_addc_u32 s25, s13, 0
s_mov_b32 s26, 0x38000
s_mov_b32 s27, 0x20000
s_mov_b32 s28, s6
s_mov_b32 s29, s7
s_mov_b32 s30, 0x1c00
s_mov_b32 s31, 0x20000
s_add_u32 s36, s12, 0x1408000
s_addc_u32 s37, s13, 0
s_mov_b32 s38, 0x4000
s_mov_b32 s39, 0x20000
s_waitcnt vmcnt(11)
s_barrier
s_add_u32 m0, s56, 94208
s_add_u32 s54, s51, 0
buffer_load_dwordx4 v2, s[16:19], s54 offen lds
v_lshrrev_b32 v16, 2, v1
v_and_b32 v17, 3, v1
v_lshlrev_b32 v16, 14, v16
s_add_u32 m0, s56, 95360
s_add_u32 s54, s51, 16384
buffer_load_dwordx4 v2, s[16:19], s54 offen lds
v_lshl_add_u32 v16, v17, 4, v16
s_lshl_b32 s59, s50, 20
s_lshl_b32 s65, s45, 10
s_add_u32 m0, s56, 96512
s_add_u32 s54, s51, 32768
buffer_load_dwordx4 v2, s[16:19], s54 offen lds
s_add_u32 s59, s59, s65
s_lshl_b32 s65, s46, 6
s_add_u32 s59, s59, s65
s_add_u32 m0, s56, 97664
s_add_u32 s54, s51, 49152
buffer_load_dwordx4 v2, s[16:19], s54 offen lds
s_mov_b32 s58, 0xffff0000
v_mov_b32 v56, 0
v_mov_b32 v57, 0
s_add_u32 m0, s57, 94208
s_nop 0
buffer_load_dwordx4 v3, s[20:23], s52 offen lds
v_mov_b32 v58, 0
v_mov_b32 v59, 0
s_add_u32 m0, s57, 95232
s_nop 0
buffer_load_dwordx4 v4, s[20:23], s52 offen lds
s_add_u32 m0, s57, 96256
s_nop 0
buffer_load_dwordx4 v5, s[20:23], s52 offen lds
s_add_u32 m0, s57, 97280
s_nop 0
buffer_load_dwordx4 v6, s[20:23], s52 offen lds
s_add_u32 m0, s57, 98304
s_nop 0
buffer_load_dwordx4 v7, s[20:23], s52 offen lds
s_add_u32 m0, s57, 99328
s_nop 0
buffer_load_dwordx4 v8, s[20:23], s52 offen lds
s_add_u32 m0, s57, 100352
s_nop 0
buffer_load_dwordx4 v9, s[20:23], s52 offen lds
s_add_u32 s51, s51, 262144
s_add_u32 s52, s52, 458752
s_waitcnt vmcnt(11)
s_barrier
s_add_u32 m0, s56, 0
s_add_u32 s54, s51, 0
buffer_load_dwordx4 v2, s[16:19], s54 offen lds
s_lshl_b32 s64, s2, 2
s_add_u32 s64, s64, s50
s_lshl_b32 s64, s64, 7
s_add_u32 s66, s8, s64
s_addc_u32 s67, s9, 0
s_add_u32 s68, s66, 3670016
s_addc_u32 s69, s67, 0
s_add_u32 m0, s56, 1152
s_add_u32 s54, s51, 16384
buffer_load_dwordx4 v2, s[16:19], s54 offen lds
s_load_dword s96, s[66:67], 0
s_add_u32 m0, s56, 2304
s_add_u32 s54, s51, 32768
buffer_load_dwordx4 v2, s[16:19], s54 offen lds
s_load_dword s97, s[66:67], 64
s_add_u32 m0, s56, 3456
s_add_u32 s54, s51, 49152
buffer_load_dwordx4 v2, s[16:19], s54 offen lds
s_load_dword s98, s[68:69], 0
s_add_u32 m0, s57, 0
s_nop 0
buffer_load_dwordx4 v3, s[20:23], s52 offen lds
s_load_dword s99, s[68:69], 64
s_add_u32 s66, s66, 131072
s_addc_u32 s67, s67, 0
s_add_u32 s68, s68, 131072
s_addc_u32 s69, s69, 0
s_add_u32 m0, s57, 1024
s_nop 0
buffer_load_dwordx4 v4, s[20:23], s52 offen lds
s_load_dword s96, s[66:67], 0
s_add_u32 m0, s57, 2048
s_nop 0
buffer_load_dwordx4 v5, s[20:23], s52 offen lds
s_load_dword s97, s[66:67], 64
s_add_u32 m0, s57, 3072
s_nop 0
buffer_load_dwordx4 v6, s[20:23], s52 offen lds
s_load_dword s98, s[68:69], 0
s_add_u32 m0, s57, 4096
s_nop 0
buffer_load_dwordx4 v7, s[20:23], s52 offen lds
s_load_dword s99, s[68:69], 64
s_add_u32 s66, s66, 131072
s_addc_u32 s67, s67, 0
s_add_u32 s68, s68, 131072
s_addc_u32 s69, s69, 0
s_add_u32 m0, s57, 5120
s_nop 0
buffer_load_dwordx4 v8, s[20:23], s52 offen lds
s_add_u32 m0, s57, 6144
s_nop 0
buffer_load_dwordx4 v9, s[20:23], s52 offen lds
s_add_u32 s51, s51, 262144
s_add_u32 s52, s52, 458752
s_add_u32 s65, s59, 0
buffer_load_dwordx4 v[20:23], v16, s[16:19], s65 offen
s_waitcnt vmcnt(12)
s_barrier
s_add_u32 m0, s56, 47104
s_add_u32 s54, s51, 0
buffer_load_dwordx4 v2, s[16:19], s54 offen lds
s_load_dword s96, s[66:67], 0
s_add_u32 m0, s56, 48256
s_add_u32 s54, s51, 16384
buffer_load_dwordx4 v2, s[16:19], s54 offen lds
s_load_dword s97, s[66:67], 64
s_add_u32 m0, s56, 49408
s_add_u32 s54, s51, 32768
buffer_load_dwordx4 v2, s[16:19], s54 offen lds
s_load_dword s98, s[68:69], 0
s_add_u32 m0, s56, 50560
s_add_u32 s54, s51, 49152
buffer_load_dwordx4 v2, s[16:19], s54 offen lds
s_load_dword s99, s[68:69], 64
s_add_u32 s66, s66, 131072
s_addc_u32 s67, s67, 0
s_add_u32 s68, s68, 131072
s_addc_u32 s69, s69, 0
s_add_u32 m0, s57, 47104
s_nop 0
buffer_load_dwordx4 v3, s[20:23], s52 offen lds
s_load_dword s96, s[66:67], 0
s_add_u32 m0, s57, 48128
s_nop 0
buffer_load_dwordx4 v4, s[20:23], s52 offen lds
s_load_dword s97, s[66:67], 64
s_add_u32 m0, s57, 49152
s_nop 0
buffer_load_dwordx4 v5, s[20:23], s52 offen lds
s_load_dword s98, s[68:69], 0
s_add_u32 m0, s57, 50176
s_nop 0
buffer_load_dwordx4 v6, s[20:23], s52 offen lds
s_load_dword s99, s[68:69], 64
s_add_u32 s66, s66, 131072
s_addc_u32 s67, s67, 0
s_add_u32 s68, s68, 131072
s_addc_u32 s69, s69, 0
s_add_u32 m0, s57, 51200
s_nop 0
buffer_load_dwordx4 v7, s[20:23], s52 offen lds
s_add_u32 m0, s57, 52224
s_nop 0
buffer_load_dwordx4 v8, s[20:23], s52 offen lds
s_add_u32 m0, s57, 53248
s_nop 0
buffer_load_dwordx4 v9, s[20:23], s52 offen lds
s_add_u32 s51, s51, 262144
s_add_u32 s52, s52, 458752
s_add_u32 s65, s59, 262144
buffer_load_dwordx4 v[24:27], v16, s[16:19], s65 offen
s_waitcnt vmcnt(13)
s_barrier
s_add_u32 m0, s56, 94208
s_add_u32 s54, s51, 0
buffer_load_dwordx4 v2, s[16:19], s54 offen lds
s_load_dword s96, s[66:67], 0
s_add_u32 m0, s56, 95360
s_add_u32 s54, s51, 16384
buffer_load_dwordx4 v2, s[16:19], s54 offen lds
s_load_dword s97, s[66:67], 64
s_add_u32 m0, s56, 96512
s_add_u32 s54, s51, 32768
buffer_load_dwordx4 v2, s[16:19], s54 offen lds
s_load_dword s98, s[68:69], 0
s_add_u32 m0, s56, 97664
s_add_u32 s54, s51, 49152
buffer_load_dwordx4 v2, s[16:19], s54 offen lds
s_load_dword s99, s[68:69], 64
s_add_u32 s66, s66, 131072
s_addc_u32 s67, s67, 0
s_add_u32 s68, s68, 131072
s_addc_u32 s69, s69, 0
s_add_u32 m0, s57, 94208
s_nop 0
buffer_load_dwordx4 v3, s[20:23], s52 offen lds
s_load_dword s96, s[66:67], 0
s_add_u32 m0, s57, 95232
s_nop 0
buffer_load_dwordx4 v4, s[20:23], s52 offen lds
s_load_dword s97, s[66:67], 64
s_add_u32 m0, s57, 96256
s_nop 0
buffer_load_dwordx4 v5, s[20:23], s52 offen lds
s_load_dword s98, s[68:69], 0
s_add_u32 m0, s57, 97280
s_nop 0
buffer_load_dwordx4 v6, s[20:23], s52 offen lds
s_load_dword s99, s[68:69], 64
s_add_u32 s66, s66, 131072
s_addc_u32 s67, s67, 0
s_add_u32 s68, s68, 131072
s_addc_u32 s69, s69, 0
s_add_u32 m0, s57, 98304
s_nop 0
buffer_load_dwordx4 v7, s[20:23], s52 offen lds
s_add_u32 m0, s57, 99328
s_nop 0
buffer_load_dwordx4 v8, s[20:23], s52 offen lds
s_add_u32 m0, s57, 100352
s_nop 0
buffer_load_dwordx4 v9, s[20:23], s52 offen lds
s_add_u32 s51, s51, 262144
s_add_u32 s52, s52, 458752
s_add_u32 s65, s59, 524288
buffer_load_dwordx4 v[28:31], v16, s[16:19], s65 offen
s_waitcnt vmcnt(13)
s_barrier
s_add_u32 m0, s56, 0
s_add_u32 s54, s51, 0
buffer_load_dwordx4 v2, s[16:19], s54 offen lds
s_load_dword s96, s[66:67], 0
s_add_u32 m0, s56, 1152
s_add_u32 s54, s51, 16384
buffer_load_dwordx4 v2, s[16:19], s54 offen lds
s_load_dword s97, s[66:67], 64
s_add_u32 m0, s56, 2304
s_add_u32 s54, s51, 32768
buffer_load_dwordx4 v2, s[16:19], s54 offen lds
s_load_dword s98, s[68:69], 0
s_add_u32 m0, s56, 3456
s_add_u32 s54, s51, 49152
buffer_load_dwordx4 v2, s[16:19], s54 offen lds
s_load_dword s99, s[68:69], 64
s_add_u32 s66, s66, 131072
s_addc_u32 s67, s67, 0
s_add_u32 s68, s68, 131072
s_addc_u32 s69, s69, 0
s_add_u32 m0, s57, 0
s_nop 0
buffer_load_dwordx4 v3, s[20:23], s52 offen lds
v_lshlrev_b32 v60, 16, v20
v_and_b32 v61, s58, v20
v_lshlrev_b32 v62, 16, v22
v_and_b32 v63, s58, v22
s_add_u32 m0, s57, 1024
s_nop 0
buffer_load_dwordx4 v4, s[20:23], s52 offen lds
v_add_f32 v56, v56, v60
v_fmac_f32 v58, v60, v60
v_add_f32 v57, v57, v62
v_fmac_f32 v59, v62, v62
s_add_u32 m0, s57, 2048
s_nop 0
buffer_load_dwordx4 v5, s[20:23], s52 offen lds
v_add_f32 v56, v56, v61
v_fmac_f32 v58, v61, v61
v_add_f32 v57, v57, v63
v_fmac_f32 v59, v63, v63
s_add_u32 m0, s57, 3072
s_nop 0
buffer_load_dwordx4 v6, s[20:23], s52 offen lds
v_lshlrev_b32 v60, 16, v21
v_and_b32 v61, s58, v21
v_lshlrev_b32 v62, 16, v23
v_and_b32 v63, s58, v23
s_add_u32 m0, s57, 4096
s_nop 0
buffer_load_dwordx4 v7, s[20:23], s52 offen lds
v_add_f32 v56, v56, v60
v_fmac_f32 v58, v60, v60
v_add_f32 v57, v57, v62
v_fmac_f32 v59, v62, v62
s_add_u32 m0, s57, 5120
s_nop 0
buffer_load_dwordx4 v8, s[20:23], s52 offen lds
v_add_f32 v56, v56, v61
v_fmac_f32 v58, v61, v61
v_add_f32 v57, v57, v63
v_fmac_f32 v59, v63, v63
s_add_u32 m0, s57, 6144
s_nop 0
buffer_load_dwordx4 v9, s[20:23], s52 offen lds
s_add_u32 s51, s51, 262144
s_add_u32 s52, s52, 458752
s_add_u32 s65, s59, 786432
buffer_load_dwordx4 v[32:35], v16, s[16:19], s65 offen
s_waitcnt vmcnt(13)
s_barrier
s_add_u32 m0, s56, 47104
s_add_u32 s54, s51, 0
buffer_load_dwordx4 v2, s[16:19], s54 offen lds
s_load_dword s96, s[66:67], 0
s_add_u32 m0, s56, 48256
s_add_u32 s54, s51, 16384
buffer_load_dwordx4 v2, s[16:19], s54 offen lds
s_load_dword s97, s[66:67], 64
s_add_u32 m0, s56, 49408
s_add_u32 s54, s51, 32768
buffer_load_dwordx4 v2, s[16:19], s54 offen lds
s_load_dword s98, s[68:69], 0
s_add_u32 m0, s56, 50560
s_add_u32 s54, s51, 49152
buffer_load_dwordx4 v2, s[16:19], s54 offen lds
s_load_dword s99, s[68:69], 64
s_add_u32 s66, s66, 131072
s_addc_u32 s67, s67, 0
s_add_u32 s68, s68, 131072
s_addc_u32 s69, s69, 0
s_add_u32 m0, s57, 47104
s_nop 0
buffer_load_dwordx4 v3, s[20:23], s52 offen lds
v_lshlrev_b32 v60, 16, v24
v_and_b32 v61, s58, v24
v_lshlrev_b32 v62, 16, v26
v_and_b32 v63, s58, v26
s_add_u32 m0, s57, 48128
s_nop 0
buffer_load_dwordx4 v4, s[20:23], s52 offen lds
v_add_f32 v56, v56, v60
v_fmac_f32 v58, v60, v60
v_add_f32 v57, v57, v62
v_fmac_f32 v59, v62, v62
s_add_u32 m0, s57, 49152
s_nop 0
buffer_load_dwordx4 v5, s[20:23], s52 offen lds
v_add_f32 v56, v56, v61
v_fmac_f32 v58, v61, v61
v_add_f32 v57, v57, v63
v_fmac_f32 v59, v63, v63
s_add_u32 m0, s57, 50176
s_nop 0
buffer_load_dwordx4 v6, s[20:23], s52 offen lds
v_lshlrev_b32 v60, 16, v25
v_and_b32 v61, s58, v25
v_lshlrev_b32 v62, 16, v27
v_and_b32 v63, s58, v27
s_add_u32 m0, s57, 51200
s_nop 0
buffer_load_dwordx4 v7, s[20:23], s52 offen lds
v_add_f32 v56, v56, v60
v_fmac_f32 v58, v60, v60
v_add_f32 v57, v57, v62
v_fmac_f32 v59, v62, v62
s_add_u32 m0, s57, 52224
s_nop 0
buffer_load_dwordx4 v8, s[20:23], s52 offen lds
v_add_f32 v56, v56, v61
v_fmac_f32 v58, v61, v61
v_add_f32 v57, v57, v63
v_fmac_f32 v59, v63, v63
s_add_u32 m0, s57, 53248
s_nop 0
buffer_load_dwordx4 v9, s[20:23], s52 offen lds
s_add_u32 s51, s51, 262144
s_add_u32 s52, s52, 458752
s_waitcnt vmcnt(12)
s_barrier
s_add_u32 m0, s56, 94208
s_add_u32 s54, s51, 0
buffer_load_dwordx4 v2, s[16:19], s54 offen lds
s_load_dword s96, s[66:67], 0
s_add_u32 m0, s56, 95360
s_add_u32 s54, s51, 16384
buffer_load_dwordx4 v2, s[16:19], s54 offen lds
s_load_dword s97, s[66:67], 64
s_add_u32 m0, s56, 96512
s_add_u32 s54, s51, 32768
buffer_load_dwordx4 v2, s[16:19], s54 offen lds
s_load_dword s98, s[68:69], 0
s_add_u32 m0, s56, 97664
s_add_u32 s54, s51, 49152
buffer_load_dwordx4 v2, s[16:19], s54 offen lds
s_load_dword s99, s[68:69], 64
s_add_u32 s66, s66, 131072
s_addc_u32 s67, s67, 0
s_add_u32 s68, s68, 131072
s_addc_u32 s69, s69, 0
s_add_u32 m0, s57, 94208
s_nop 0
buffer_load_dwordx4 v3, s[20:23], s52 offen lds
v_lshlrev_b32 v60, 16, v28
v_and_b32 v61, s58, v28
v_lshlrev_b32 v62, 16, v30
v_and_b32 v63, s58, v30
s_add_u32 m0, s57, 95232
s_nop 0
buffer_load_dwordx4 v4, s[20:23], s52 offen lds
v_add_f32 v56, v56, v60
v_fmac_f32 v58, v60, v60
v_add_f32 v57, v57, v62
v_fmac_f32 v59, v62, v62
s_add_u32 m0, s57, 96256
s_nop 0
buffer_load_dwordx4 v5, s[20:23], s52 offen lds
v_add_f32 v56, v56, v61
v_fmac_f32 v58, v61, v61
v_add_f32 v57, v57, v63
v_fmac_f32 v59, v63, v63
s_add_u32 m0, s57, 97280
s_nop 0
buffer_load_dwordx4 v6, s[20:23], s52 offen lds
v_lshlrev_b32 v60, 16, v29
v_and_b32 v61, s58, v29
v_lshlrev_b32 v62, 16, v31
v_and_b32 v63, s58, v31
s_add_u32 m0, s57, 98304
s_nop 0
buffer_load_dwordx4 v7, s[20:23], s52 offen lds
v_add_f32 v56, v56, v60
v_fmac_f32 v58, v60, v60
v_add_f32 v57, v57, v62
v_fmac_f32 v59, v62, v62
s_add_u32 m0, s57, 99328
s_nop 0
buffer_load_dwordx4 v8, s[20:23], s52 offen lds
v_add_f32 v56, v56, v61
v_fmac_f32 v58, v61, v61
v_add_f32 v57, v57, v63
v_fmac_f32 v59, v63, v63
s_add_u32 m0, s57, 100352
s_nop 0
buffer_load_dwordx4 v9, s[20:23], s52 offen lds
s_add_u32 s51, s51, 262144
s_add_u32 s52, s52, 458752
s_waitcnt vmcnt(11)
s_barrier
s_add_u32 m0, s56, 0
s_add_u32 s54, s51, 0
buffer_load_dwordx4 v2, s[16:19], s54 offen lds
s_load_dword s96, s[66:67], 0
s_add_u32 m0, s56, 1152
s_add_u32 s54, s51, 16384
buffer_load_dwordx4 v2, s[16:19], s54 offen lds
s_load_dword s97, s[66:67], 64
s_add_u32 m0, s56, 2304
s_add_u32 s54, s51, 32768
buffer_load_dwordx4 v2, s[16:19], s54 offen lds
s_load_dword s98, s[68:69], 0
s_add_u32 m0, s56, 3456
s_add_u32 s54, s51, 49152
buffer_load_dwordx4 v2, s[16:19], s54 offen lds
s_load_dword s99, s[68:69], 64
s_add_u32 s66, s66, 131072
s_addc_u32 s67, s67, 0
s_add_u32 s68, s68, 131072
s_addc_u32 s69, s69, 0
s_add_u32 m0, s57, 0
s_nop 0
buffer_load_dwordx4 v3, s[20:23], s52 offen lds
v_lshlrev_b32 v60, 16, v32
v_and_b32 v61, s58, v32
v_lshlrev_b32 v62, 16, v34
v_and_b32 v63, s58, v34
s_add_u32 m0, s57, 1024
s_nop 0
buffer_load_dwordx4 v4, s[20:23], s52 offen lds
v_add_f32 v56, v56, v60
v_fmac_f32 v58, v60, v60
v_add_f32 v57, v57, v62
v_fmac_f32 v59, v62, v62
s_add_u32 m0, s57, 2048
s_nop 0
buffer_load_dwordx4 v5, s[20:23], s52 offen lds
v_add_f32 v56, v56, v61
v_fmac_f32 v58, v61, v61
v_add_f32 v57, v57, v63
v_fmac_f32 v59, v63, v63
s_add_u32 m0, s57, 3072
s_nop 0
buffer_load_dwordx4 v6, s[20:23], s52 offen lds
v_lshlrev_b32 v60, 16, v33
v_and_b32 v61, s58, v33
v_lshlrev_b32 v62, 16, v35
v_and_b32 v63, s58, v35
s_add_u32 m0, s57, 4096
s_nop 0
buffer_load_dwordx4 v7, s[20:23], s52 offen lds
v_add_f32 v56, v56, v60
v_fmac_f32 v58, v60, v60
v_add_f32 v57, v57, v62
v_fmac_f32 v59, v62, v62
s_add_u32 m0, s57, 5120
s_nop 0
buffer_load_dwordx4 v8, s[20:23], s52 offen lds
v_add_f32 v56, v56, v61
v_fmac_f32 v58, v61, v61
v_add_f32 v57, v57, v63
v_fmac_f32 v59, v63, v63
s_add_u32 m0, s57, 6144
s_nop 0
buffer_load_dwordx4 v9, s[20:23], s52 offen lds
s_add_u32 s51, s51, 262144
s_add_u32 s52, s52, 458752
s_waitcnt vmcnt(11)
s_barrier
s_add_u32 m0, s56, 47104
s_add_u32 s54, s51, 0
buffer_load_dwordx4 v2, s[16:19], s54 offen lds
v_add_f32_dpp v56, v56, v56 row_ror:4 row_mask:0xf bank_mask:0xf
v_add_f32_dpp v57, v57, v57 row_ror:4 row_mask:0xf bank_mask:0xf
v_add_f32_dpp v58, v58, v58 row_ror:4 row_mask:0xf bank_mask:0xf
v_add_f32_dpp v59, v59, v59 row_ror:4 row_mask:0xf bank_mask:0xf
s_add_u32 m0, s56, 48256
s_add_u32 s54, s51, 16384
buffer_load_dwordx4 v2, s[16:19], s54 offen lds
v_add_f32_dpp v56, v56, v56 row_ror:8 row_mask:0xf bank_mask:0xf
v_add_f32_dpp v57, v57, v57 row_ror:8 row_mask:0xf bank_mask:0xf
v_add_f32_dpp v58, v58, v58 row_ror:8 row_mask:0xf bank_mask:0xf
v_add_f32_dpp v59, v59, v59 row_ror:8 row_mask:0xf bank_mask:0xf
s_add_u32 m0, s56, 49408
s_add_u32 s54, s51, 32768
buffer_load_dwordx4 v2, s[16:19], s54 offen lds
s_add_u32 m0, s56, 50560
s_add_u32 s54, s51, 49152
buffer_load_dwordx4 v2, s[16:19], s54 offen lds
s_add_u32 m0, s57, 47104
s_nop 0
buffer_load_dwordx4 v3, s[20:23], s52 offen lds
s_add_u32 m0, s57, 48128
s_nop 0
buffer_load_dwordx4 v4, s[20:23], s52 offen lds
s_add_u32 m0, s57, 49152
s_nop 0
buffer_load_dwordx4 v5, s[20:23], s52 offen lds
s_add_u32 m0, s57, 50176
s_nop 0
buffer_load_dwordx4 v6, s[20:23], s52 offen lds
s_add_u32 m0, s57, 51200
s_nop 0
buffer_load_dwordx4 v7, s[20:23], s52 offen lds
s_add_u32 m0, s57, 52224
s_nop 0
buffer_load_dwordx4 v8, s[20:23], s52 offen lds
s_add_u32 m0, s57, 53248
s_nop 0
buffer_load_dwordx4 v9, s[20:23], s52 offen lds
s_add_u32 s51, s51, 262144
s_add_u32 s52, s52, 458752
s_waitcnt vmcnt(11)
s_barrier
s_add_u32 m0, s56, 94208
s_add_u32 s54, s51, 0
buffer_load_dwordx4 v2, s[16:19], s54 offen lds
v_mov_b32 v60, v56
v_mov_b32 v61, v57
v_mov_b32 v62, v58
v_mov_b32 v63, v59
s_add_u32 m0, s56, 95360
s_add_u32 s54, s51, 16384
buffer_load_dwordx4 v2, s[16:19], s54 offen lds
v_permlane16_swap_b32 v56, v60
v_permlane16_swap_b32 v57, v61
v_permlane16_swap_b32 v58, v62
v_permlane16_swap_b32 v59, v63
s_add_u32 m0, s56, 96512
s_add_u32 s54, s51, 32768
buffer_load_dwordx4 v2, s[16:19], s54 offen lds
v_add_f32 v56, v56, v60
v_add_f32 v57, v57, v61
v_add_f32 v58, v58, v62
v_add_f32 v59, v59, v63
s_add_u32 m0, s56, 97664
s_add_u32 s54, s51, 49152
buffer_load_dwordx4 v2, s[16:19], s54 offen lds
v_mov_b32 v60, v56
v_mov_b32 v61, v57
v_mov_b32 v62, v58
v_mov_b32 v63, v59
s_add_u32 m0, s57, 94208
s_nop 0
buffer_load_dwordx4 v3, s[20:23], s52 offen lds
v_permlane32_swap_b32 v56, v60
v_permlane32_swap_b32 v57, v61
v_permlane32_swap_b32 v58, v62
v_permlane32_swap_b32 v59, v63
s_add_u32 m0, s57, 95232
s_nop 0
buffer_load_dwordx4 v4, s[20:23], s52 offen lds
v_add_f32 v56, v56, v60
v_add_f32 v57, v57, v61
v_add_f32 v58, v58, v62
v_add_f32 v59, v59, v63
s_add_u32 m0, s57, 96256
s_nop 0
buffer_load_dwordx4 v5, s[20:23], s52 offen lds
v_and_b32 v17, 3, v1
v_lshlrev_b32 v17, 4, v17
s_lshl_b32 s64, s50, 6
s_add_u32 s64, s64, 145792
s_add_u32 m0, s57, 97280
s_nop 0
buffer_load_dwordx4 v6, s[20:23], s52 offen lds
v_add_u32 v17, s64, v17
v_mov_b32 v60, v56
v_mov_b32 v61, v58
v_mov_b32 v62, v57
s_add_u32 m0, s57, 98304
s_nop 0
buffer_load_dwordx4 v7, s[20:23], s52 offen lds
v_mov_b32 v63, v59
ds_write_b128 v17, v[60:63]
s_add_u32 m0, s57, 99328
s_nop 0
buffer_load_dwordx4 v8, s[20:23], s52 offen lds
s_add_u32 m0, s57, 100352
s_nop 0
buffer_load_dwordx4 v9, s[20:23], s52 offen lds
s_add_u32 s51, s51, 262144
s_add_u32 s52, s52, 458752
s_waitcnt vmcnt(11) lgkmcnt(0)
s_barrier
s_add_u32 m0, s56, 0
s_add_u32 s54, s51, 0
buffer_load_dwordx4 v2, s[16:19], s54 offen lds
s_add_u32 m0, s56, 1152
s_add_u32 s54, s51, 16384
buffer_load_dwordx4 v2, s[16:19], s54 offen lds
s_add_u32 m0, s56, 2304
s_add_u32 s54, s51, 32768
buffer_load_dwordx4 v2, s[16:19], s54 offen lds
s_add_u32 m0, s56, 3456
s_add_u32 s54, s51, 49152
buffer_load_dwordx4 v2, s[16:19], s54 offen lds
s_add_u32 m0, s57, 0
s_nop 0
buffer_load_dwordx4 v3, s[20:23], s52 offen lds
s_add_u32 m0, s57, 1024
s_nop 0
buffer_load_dwordx4 v4, s[20:23], s52 offen lds
s_add_u32 m0, s57, 2048
s_nop 0
buffer_load_dwordx4 v5, s[20:23], s52 offen lds
s_add_u32 m0, s57, 3072
s_nop 0
buffer_load_dwordx4 v6, s[20:23], s52 offen lds
s_add_u32 m0, s57, 4096
s_nop 0
buffer_load_dwordx4 v7, s[20:23], s52 offen lds
s_add_u32 m0, s57, 5120
s_nop 0
buffer_load_dwordx4 v8, s[20:23], s52 offen lds
s_add_u32 m0, s57, 6144
s_nop 0
buffer_load_dwordx4 v9, s[20:23], s52 offen lds
s_add_u32 s51, s51, 262144
s_add_u32 s52, s52, 458752
v_and_b32 v17, 1, v1
v_lshlrev_b32 v17, 3, v17
s_lshl_b32 s64, s50, 4
s_add_u32 s64, s64, 145792
v_add_u32 v18, s64, v17
ds_read_b64 v[56:57], v18 offset:0
ds_read_b64 v[58:59], v18 offset:64
ds_read_b64 v[60:61], v18 offset:128
ds_read_b64 v[62:63], v18 offset:192
s_waitcnt lgkmcnt(0)
v_add_f32 v56, v56, v58
v_add_f32 v57, v57, v59
v_add_f32 v56, v56, v60
v_add_f32 v57, v57, v61
v_add_f32 v56, v56, v62
v_add_f32 v57, v57, v63
s_mov_b32 s62, 0x3a800000
s_mov_b32 s63, 0x3727c5ac
v_mul_f32 v56, s62, v56
v_mul_f32 v57, s62, v57
v_fma_f32 v57, -v56, v56, v57
v_max_f32 v57, 0, v57
v_add_f32 v58, s63, v57
v_rsq_f32 v58, v58
s_nop 0
v_mul_f32 v59, v57, v58
v_mul_f32 v59, v59, v58
v_add_f32 v59, s63, v59
v_rsq_f32 v59, v59
s_nop 0
v_mul_f32 v58, v58, v59
v_mul_f32 v59, v58, v56
s_lshl_b32 s64, s45, 10
s_lshl_b32 s65, s46, 6
s_add_u32 s64, s64, s65
s_lshl_b32 s65, s50, 4
s_add_u32 s64, s64, s65
s_mov_b64 s[62:63], exec
s_mov_b64 exec, 3
buffer_store_dwordx2 v[58:59], v17, s[36:39], s64 offen sc1
s_mov_b64 exec, s[62:63]
s_waitcnt vmcnt(12)
s_barrier
s_add_u32 m0, s56, 47104
s_add_u32 s54, s51, 0
buffer_load_dwordx4 v2, s[16:19], s54 offen lds
s_cmp_lg_u32 s50, 1
s_cbranch_scc1 CPFSKIP_g1b
s_getpc_b64 s[60:61]
CPF_g1b:
s_sub_u32 s60, s60, CPF_g1b-CODE_G1A_T
s_subb_u32 s61, s61, 0
s_lshr_b32 s62, s2, 3
s_mul_i32 s62, s62, 256
s_min_u32 s63, s62, CODE_G1A_E-CODE_G1A_T-4
s_load_dword s96, s[60:61], s63
s_add_u32 s62, s62, 64
s_min_u32 s63, s62, CODE_G1A_E-CODE_G1A_T-4
s_load_dword s97, s[60:61], s63
s_add_u32 s62, s62, 64
s_min_u32 s63, s62, CODE_G1A_E-CODE_G1A_T-4
s_load_dword s98, s[60:61], s63
s_add_u32 s62, s62, 64
s_min_u32 s63, s62, CODE_G1A_E-CODE_G1A_T-4
s_load_dword s99, s[60:61], s63
s_add_u32 s62, s62, 64
CPFSKIP_g1b:
s_add_u32 m0, s56, 48256
s_add_u32 s54, s51, 16384
buffer_load_dwordx4 v2, s[16:19], s54 offen lds
s_add_u32 m0, s56, 49408
s_add_u32 s54, s51, 32768
buffer_load_dwordx4 v2, s[16:19], s54 offen lds
s_add_u32 m0, s56, 50560
s_add_u32 s54, s51, 49152
buffer_load_dwordx4 v2, s[16:19], s54 offen lds
s_add_u32 m0, s57, 47104
s_nop 0
buffer_load_dwordx4 v3, s[20:23], s52 offen lds
s_add_u32 m0, s57, 48128
s_nop 0
buffer_load_dwordx4 v4, s[20:23], s52 offen lds
s_add_u32 m0, s57, 49152
s_nop 0
buffer_load_dwordx4 v5, s[20:23], s52 offen lds
s_add_u32 m0, s57, 50176
s_nop 0
buffer_load_dwordx4 v6, s[20:23], s52 offen lds
s_add_u32 m0, s57, 51200
s_nop 0
buffer_load_dwordx4 v7, s[20:23], s52 offen lds
s_add_u32 m0, s57, 52224
s_nop 0
buffer_load_dwordx4 v8, s[20:23], s52 offen lds
s_add_u32 m0, s57, 53248
s_nop 0
buffer_load_dwordx4 v9, s[20:23], s52 offen lds
s_add_u32 s51, s51, 262144
s_add_u32 s52, s52, 458752
v_and_b32 v18, 15, v1
v_min_u32 v18, 13, v18
v_lshrrev_b32 v19, 4, v1
v_mul_u32_u24 v19, 57344, v19
v_lshl_add_u32 v19, v18, 4, v19
s_mul_i32 s64, s50, 224
s_mul_i32 s65, s46, 896
s_add_u32 s64, s64, s65
s_add_u32 s65, s64, 0
buffer_load_dwordx4 v[36:39], v19, s[24:27], s65 offen
s_add_u32 s65, s64, 14336
buffer_load_dwordx4 v[40:43], v19, s[24:27], s65 offen
s_add_u32 s65, s64, 28672
buffer_load_dwordx4 v[44:47], v19, s[24:27], s65 offen
s_add_u32 s65, s64, 43008
buffer_load_dwordx4 v[48:51], v19, s[24:27], s65 offen
v_min_u32 v52, 55, v1
s_mul_i32 s64, s50, 56
v_add_u32 v52, s64, v52
v_lshlrev_b32 v53, 1, v52
s_mul_i32 s65, s46, 448
buffer_load_ushort v54, v53, s[28:31], s65 offen
s_waitcnt vmcnt(17)
s_barrier
s_add_u32 m0, s56, 94208
s_add_u32 s54, s51, 0
buffer_load_dwordx4 v2, s[16:19], s54 offen lds
s_cmp_lg_u32 s50, 0
s_cbranch_scc1 CPFSKIP_g2
s_getpc_b64 s[60:61]
CPF_g2:
s_add_u32 s60, s60, CODE_G2_S-CPF_g2
s_addc_u32 s61, s61, 0
s_lshr_b32 s62, s2, 3
s_mul_i32 s62, s62, 320
s_min_u32 s63, s62, CODE_G2_E-CODE_G2_S-4
s_load_dword s96, s[60:61], s63
s_add_u32 s62, s62, 64
s_min_u32 s63, s62, CODE_G2_E-CODE_G2_S-4
s_load_dword s97, s[60:61], s63
s_add_u32 s62, s62, 64
s_min_u32 s63, s62, CODE_G2_E-CODE_G2_S-4
s_load_dword s98, s[60:61], s63
s_add_u32 s62, s62, 64
s_min_u32 s63, s62, CODE_G2_E-CODE_G2_S-4
s_load_dword s99, s[60:61], s63
s_add_u32 s62, s62, 64
s_min_u32 s63, s62, CODE_G2_E-CODE_G2_S-4
s_load_dword s96, s[60:61], s63
s_add_u32 s62, s62, 64
CPFSKIP_g2:
s_add_u32 m0, s56, 95360
s_add_u32 s54, s51, 16384
buffer_load_dwordx4 v2, s[16:19], s54 offen lds
s_add_u32 m0, s56, 96512
s_add_u32 s54, s51, 32768
buffer_load_dwordx4 v2, s[16:19], s54 offen lds
s_add_u32 m0, s56, 97664
s_add_u32 s54, s51, 49152
buffer_load_dwordx4 v2, s[16:19], s54 offen lds
s_add_u32 m0, s57, 94208
s_nop 0
buffer_load_dwordx4 v3, s[20:23], s52 offen lds
s_add_u32 m0, s57, 95232
s_nop 0
buffer_load_dwordx4 v4, s[20:23], s52 offen lds
s_add_u32 m0, s57, 96256
s_nop 0
buffer_load_dwordx4 v5, s[20:23], s52 offen lds
s_add_u32 m0, s57, 97280
s_nop 0
buffer_load_dwordx4 v6, s[20:23], s52 offen lds
s_add_u32 m0, s57, 98304
s_nop 0
buffer_load_dwordx4 v7, s[20:23], s52 offen lds
s_add_u32 m0, s57, 99328
s_nop 0
buffer_load_dwordx4 v8, s[20:23], s52 offen lds
s_add_u32 m0, s57, 100352
s_nop 0
buffer_load_dwordx4 v9, s[20:23], s52 offen lds
s_add_u32 s51, s51, 262144
s_add_u32 s52, s52, 458752
s_waitcnt vmcnt(16)
s_barrier
s_add_u32 m0, s56, 0
s_add_u32 s54, s51, 0
buffer_load_dwordx4 v2, s[16:19], s54 offen lds
s_add_u32 m0, s56, 1152
s_add_u32 s54, s51, 16384
buffer_load_dwordx4 v2, s[16:19], s54 offen lds
s_add_u32 m0, s56, 2304
s_add_u32 s54, s51, 32768
buffer_load_dwordx4 v2, s[16:19], s54 offen lds
s_add_u32 m0, s56, 3456
s_add_u32 s54, s51, 49152
buffer_load_dwordx4 v2, s[16:19], s54 offen lds
s_add_u32 m0, s57, 0
s_nop 0
buffer_load_dwordx4 v3, s[20:23], s52 offen lds
s_add_u32 m0, s57, 1024
s_nop 0
buffer_load_dwordx4 v4, s[20:23], s52 offen lds
s_add_u32 m0, s57, 2048
s_nop 0
buffer_load_dwordx4 v5, s[20:23], s52 offen lds
s_add_u32 m0, s57, 3072
s_nop 0
buffer_load_dwordx4 v6, s[20:23], s52 offen lds
s_add_u32 m0, s57, 4096
s_nop 0
buffer_load_dwordx4 v7, s[20:23], s52 offen lds
s_add_u32 m0, s57, 5120
s_nop 0
buffer_load_dwordx4 v8, s[20:23], s52 offen lds
s_add_u32 m0, s57, 6144
s_nop 0
buffer_load_dwordx4 v9, s[20:23], s52 offen lds
s_add_u32 s51, s51, 262144
s_add_u32 s52, s52, 458752
s_waitcnt vmcnt(11)
s_barrier
v_add_f32 v36, v36, v40
v_add_f32 v37, v37, v41
v_add_f32 v38, v38, v42
v_add_f32 v39, v39, v43
v_add_f32 v36, v36, v44
v_add_f32 v37, v37, v45
v_add_f32 v38, v38, v46
v_add_f32 v39, v39, v47
v_add_f32 v36, v36, v48
v_add_f32 v37, v37, v49
v_add_f32 v38, v38, v50
v_add_f32 v39, v39, v51
v_mov_b32 v40, v36
v_mov_b32 v41, v37
v_mov_b32 v42, v38
v_mov_b32 v43, v39
v_permlane16_swap_b32 v36, v40
v_permlane16_swap_b32 v37, v41
v_permlane16_swap_b32 v38, v42
v_permlane16_swap_b32 v39, v43
v_add_f32 v36, v36, v40
v_add_f32 v37, v37, v41
v_add_f32 v38, v38, v42
v_add_f32 v39, v39, v43
v_mov_b32 v40, v36
v_mov_b32 v41, v37
v_mov_b32 v42, v38
v_mov_b32 v43, v39
v_permlane32_swap_b32 v36, v40
v_permlane32_swap_b32 v37, v41
v_permlane32_swap_b32 v38, v42
v_permlane32_swap_b32 v39, v43
v_add_f32 v36, v36, v40
v_add_f32 v37, v37, v41
v_add_f32 v38, v38, v42
v_add_f32 v39, v39, v43
s_mul_i32 s64, s50, 224
s_add_u32 s64, s64, 141312
v_lshlrev_b32 v19, 4, v18
v_add_u32 v19, s64, v19
ds_write_b128 v19, v[36:39]
v_lshlrev_b32 v54, 16, v54
v_lshlrev_b32 v52, 2, v52
v_add_u32 v52, 144896, v52
ds_write_b32 v52, v54
s_waitcnt vmcnt(0) lgkmcnt(0)
s_barrier
s_and_b32 s60, s2, 1
s_lshr_b32 s61, s2, 5
s_lshl_b32 s57, s50, 12
v_lshrrev_b32 v16, 4, v1
v_and_b32 v17, 15, v1
v_add_u32 v18, 0, v16
v_lshlrev_b32 v18, 1, v18
v_xor_b32 v18, v17, v18
v_lshlrev_b32 v18, 4, v18
v_lshl_add_u32 v3, v16, 11, v18
v_add_u32 v18, 4, v16
v_lshlrev_b32 v18, 1, v18
v_xor_b32 v18, v17, v18
v_lshlrev_b32 v18, 4, v18
v_lshl_add_u32 v4, v16, 11, v18
s_mul_i32 s52, s60, 3670016
s_lshl_b32 s64, s50, 15
s_add_u32 s52, s52, s64
s_lshl_b32 s64, s61, 8
s_add_u32 s52, s52, s64
s_mov_b32 s20, s8
s_mov_b32 s21, s9
s_mov_b32 s22, 0x700000
s_mov_b32 s23, 0x20000
s_add_u32 m0, s57, 49152
s_add_u32 s54, s52, 131072
buffer_load_dwordx4 v3, s[20:23], s54 offen lds
s_add_u32 m0, s57, 50176
s_add_u32 s54, s52, 139264
buffer_load_dwordx4 v4, s[20:23], s54 offen lds
s_add_u32 m0, s57, 51200
s_add_u32 s54, s52, 147456
buffer_load_dwordx4 v3, s[20:23], s54 offen lds
s_add_u32 m0, s57, 52224
s_add_u32 s54, s52, 155648
buffer_load_dwordx4 v4, s[20:23], s54 offen lds
s_add_u32 m0, s57, 81920
s_add_u32 s54, s52, 262144
buffer_load_dwordx4 v3, s[20:23], s54 offen lds
s_add_u32 m0, s57, 82944
s_add_u32 s54, s52, 270336
buffer_load_dwordx4 v4, s[20:23], s54 offen lds
s_add_u32 m0, s57, 83968
s_add_u32 s54, s52, 278528
buffer_load_dwordx4 v3, s[20:23], s54 offen lds
s_add_u32 m0, s57, 84992
s_add_u32 s54, s52, 286720
buffer_load_dwordx4 v4, s[20:23], s54 offen lds
s_add_u32 m0, s57, 114688
s_add_u32 s54, s52, 393216
buffer_load_dwordx4 v3, s[20:23], s54 offen lds
s_add_u32 m0, s57, 115712
s_add_u32 s54, s52, 401408
buffer_load_dwordx4 v4, s[20:23], s54 offen lds
s_add_u32 m0, s57, 116736
s_add_u32 s54, s52, 409600
buffer_load_dwordx4 v3, s[20:23], s54 offen lds
s_add_u32 m0, s57, 117760
s_add_u32 s54, s52, 417792
buffer_load_dwordx4 v4, s[20:23], s54 offen lds
s_add_u32 m0, s57, 147456
s_add_u32 s54, s52, 524288
buffer_load_dwordx4 v3, s[20:23], s54 offen lds
s_add_u32 m0, s57, 148480
s_add_u32 s54, s52, 532480
buffer_load_dwordx4 v4, s[20:23], s54 offen lds
s_add_u32 m0, s57, 149504
s_add_u32 s54, s52, 540672
buffer_load_dwordx4 v3, s[20:23], s54 offen lds
s_add_u32 m0, s57, 150528
s_add_u32 s54, s52, 548864
buffer_load_dwordx4 v4, s[20:23], s54 offen lds
s_barrier
s_add_u32 m0, s57, 16384
s_add_u32 s54, s52, 0
buffer_load_dwordx4 v3, s[20:23], s54 offen lds
s_add_u32 m0, s57, 17408
s_add_u32 s54, s52, 8192
buffer_load_dwordx4 v4, s[20:23], s54 offen lds
s_add_u32 m0, s57, 18432
s_add_u32 s54, s52, 16384
buffer_load_dwordx4 v3, s[20:23], s54 offen lds
s_add_u32 m0, s57, 19456
s_add_u32 s54, s52, 24576
buffer_load_dwordx4 v4, s[20:23], s54 offen lds
s_branch P2_DONE
CODE_G1_E:
P2_DONE:
s_waitcnt vmcnt(0)
s_barrier
s_cmp_lg_u32 s44, 4
s_cbranch_scc1 P2_ARR
s_add_u32 s16, s12, 0x14a0000
s_addc_u32 s17, s13, 0
s_mov_b32 s18, 0x8000
s_mov_b32 s19, 0x20000
s_lshl_b32 s60, s45, 4
s_add_u32 s60, s60, s46
s_lshl_b32 s60, s60, 7
v_mov_b32 v8, 1
v_mov_b32 v9, 0
s_mov_b64 s[62:63], exec
s_mov_b64 exec, 1
buffer_store_dword v8, v9, s[16:19], s60 offen sc1
s_mov_b64 exec, s[62:63]
P2_ARR:
CODE_G2_S:
v_and_b32 v1, 63, v0
v_lshrrev_b32 v2, 6, v0
s_nop 0
v_readfirstlane_b32 s44, v2
s_and_b32 s47, s2, 7
s_lshr_b32 s48, s2, 3
s_and_b32 s43, s47, 1
s_lshr_b32 s45, s47, 1
s_lshl_b32 s45, s45, 2
s_and_b32 s49, s48, 3
s_add_u32 s45, s45, s49
s_lshr_b32 s46, s48, 2
s_cmp_lg_u32 s44, 4
s_cbranch_scc1 P3_WAIT
s_add_u32 s16, s12, 0x14a0000
s_addc_u32 s17, s13, 0
s_mov_b32 s18, 0x8000
s_mov_b32 s19, 0x20000
s_lshl_b32 s60, s45, 11
v_and_b32 v10, 15, v1
v_lshlrev_b32 v10, 7, v10
v_add_u32 v10, s60, v10
s_mov_b32 s61, 400000
P3_POLL:
buffer_load_dword v11, v10, s[16:19], 0 offen sc1
s_waitcnt vmcnt(0)
v_cmp_gt_u32 vcc, 1, v11
s_nop 4
s_cbranch_vccz P3_POLL_OK
s_sub_u32 s61, s61, 1
s_cmp_lg_u32 s61, 0
s_cbranch_scc1 P3_POLL
P3_POLL_OK:
P3_WAIT:
s_barrier
s_cmp_ge_u32 s44, 4
s_cbranch_scc1 G2_DMA
s_and_b32 s47, s44, 1
s_lshr_b32 s48, s44, 1
v_lshrrev_b32 v12, 4, v1
v_and_b32 v13, 15, v1
v_lshlrev_b32 v14, 4, v1
s_lshl_b32 s64, s47, 13
s_lshl_b32 s65, s43, 12
s_add_u32 s66, s64, s65
s_sub_u32 s67, s64, s65
v_add_u32 v2, s66, v14
v_add_u32 v11, s67, v14
v_lshrrev_b32 v14, 2, v13
v_lshl_add_u32 v14, v12, 2, v14
v_and_b32 v15, 7, v14
v_lshlrev_b32 v14, 8, v14
v_and_b32 v7, 3, v1
v_lshl_add_u32 v14, v7, 3, v14
v_add_u32 v14, 16384, v14
s_lshl_b32 s68, s48, 2
s_add_u32 s69, s68, 0
v_xor_b32 v7, s69, v15
v_lshl_add_u32 v3, v7, 5, v14
s_add_u32 s69, s68, 1
v_xor_b32 v7, s69, v15
v_lshl_add_u32 v4, v7, 5, v14
s_add_u32 s69, s68, 2
v_xor_b32 v7, s69, v15
v_lshl_add_u32 v5, v7, 5, v14
s_add_u32 s69, s68, 3
v_xor_b32 v7, s69, v15
v_lshl_add_u32 v6, v7, 5, v14
s_mov_b32 s50, 0
s_add_u32 s24, s12, 0x1000000
s_addc_u32 s25, s13, 0
s_mov_b32 s26, 0x400000
s_mov_b32 s27, 0x20000
s_mov_b32 s28, s14
s_mov_b32 s29, s15
s_mov_b32 s30, 0x800
s_mov_b32 s31, 0x20000
s_mov_b32 s32, s10
s_mov_b32 s33, s11
s_mov_b32 s34, 0x400000
s_mov_b32 s35, 0x20000
s_add_u32 s52, s12, 0x1480000
s_addc_u32 s53, s13, 0
s_mov_b32 s54, 0x20000
s_mov_b32 s55, 0x20000
s_lshl_b32 s70, s45, 7
s_lshl_b32 s65, s47, 6
s_add_u32 s70, s70, s65
s_lshl_b32 s65, s43, 5
s_add_u32 s71, s70, s65
s_xor_b32 s66, s65, 32
s_add_u32 s70, s70, s66
s_lshl_b32 s65, s46, 5
s_lshl_b32 s66, s48, 4
s_add_u32 s65, s65, s66
s_lshl_b32 s42, s65, 14
v_lshlrev_b32 v8, 14, v12
v_lshl_add_u32 v8, v13, 3, v8
s_lshl_b32 s66, s71, 3
s_add_u32 s41, s42, s66
s_lshl_b32 s66, s70, 3
s_add_u32 s40, s42, s66
s_add_u32 s66, s41, 0
buffer_load_dwordx2 v[208:209], v8, s[24:27], s66 offen
s_add_u32 s66, s41, 128
buffer_load_dwordx2 v[210:211], v8, s[24:27], s66 offen
s_add_u32 s66, s41, 65536
buffer_load_dwordx2 v[212:213], v8, s[24:27], s66 offen
s_add_u32 s66, s41, 65664
buffer_load_dwordx2 v[214:215], v8, s[24:27], s66 offen
s_add_u32 s66, s41, 131072
buffer_load_dwordx2 v[216:217], v8, s[24:27], s66 offen
s_add_u32 s66, s41, 131200
buffer_load_dwordx2 v[218:219], v8, s[24:27], s66 offen
s_add_u32 s66, s41, 196608
buffer_load_dwordx2 v[220:221], v8, s[24:27], s66 offen
s_add_u32 s66, s41, 196736
buffer_load_dwordx2 v[222:223], v8, s[24:27], s66 offen
v_lshlrev_b32 v9, 3, v12
s_lshl_b32 s65, s46, 8
s_lshl_b32 s66, s48, 7
s_add_u32 s65, s65, s66
buffer_load_dwordx2 v[224:225], v9, s[28:31], s65 offen offset:0
buffer_load_dwordx2 v[226:227], v9, s[28:31], s65 offen offset:32
buffer_load_dwordx2 v[228:229], v9, s[28:31], s65 offen offset:64
buffer_load_dwordx2 v[230:231], v9, s[28:31], s65 offen offset:96
s_barrier
ds_read_b64_tr_b16 v[32:33], v3 offset:0
ds_read_b64_tr_b16 v[34:35], v3 offset:4096
ds_read_b128 v[16:19], v2 offset:0
ds_read_b128 v[20:23], v2 offset:2048
ds_read_b64_tr_b16 v[36:37], v4 offset:0
ds_read_b64_tr_b16 v[38:39], v4 offset:4096
ds_read_b128 v[24:27], v11 offset:4096
ds_read_b128 v[28:31], v11 offset:6144
ds_read_b64_tr_b16 v[40:41], v5 offset:0
ds_read_b64_tr_b16 v[42:43], v5 offset:4096
ds_read_b64_tr_b16 v[44:45], v6 offset:0
ds_read_b64_tr_b16 v[46:47], v6 offset:4096
ds_read_b64_tr_b16 v[64:65], v3 offset:8192
ds_read_b64_tr_b16 v[66:67], v3 offset:12288
ds_read_b128 v[48:51], v2 offset:1024
ds_read_b128 v[52:55], v2 offset:3072
ds_read_b64_tr_b16 v[68:69], v4 offset:8192
ds_read_b64_tr_b16 v[70:71], v4 offset:12288
ds_read_b128 v[56:59], v11 offset:5120
ds_read_b128 v[60:63], v11 offset:7168
ds_read_b64_tr_b16 v[72:73], v5 offset:8192
ds_read_b64_tr_b16 v[74:75], v5 offset:12288
ds_read_b64_tr_b16 v[76:77], v6 offset:8192
ds_read_b64_tr_b16 v[78:79], v6 offset:12288
s_add_u32 s60, s50, 32768
s_cmp_eq_u32 s60, 163840
s_cselect_b32 s60, 0, s60
s_sub_u32 s59, s60, s50
s_mov_b32 s50, s60
v_add_u32 v2, s59, v2
v_add_u32 v11, s59, v11
v_add_u32 v3, s59, v3
v_add_u32 v4, s59, v4
v_add_u32 v5, s59, v5
v_add_u32 v6, s59, v6
s_waitcnt lgkmcnt(0)
s_barrier
v_mfma_f32_16x16x32_bf16 v[144:147], v[32:35], v[16:19], 0
ds_read_b64_tr_b16 v[96:97], v3 offset:0
v_mfma_f32_16x16x32_bf16 v[148:151], v[32:35], v[20:23], 0
ds_read_b64_tr_b16 v[98:99], v3 offset:4096
v_mfma_f32_16x16x32_bf16 v[152:155], v[32:35], v[24:27], 0
ds_read_b128 v[80:83], v2 offset:0
v_mfma_f32_16x16x32_bf16 v[156:159], v[32:35], v[28:31], 0
ds_read_b128 v[84:87], v2 offset:2048
v_mfma_f32_16x16x32_bf16 v[160:163], v[36:39], v[16:19], 0
ds_read_b64_tr_b16 v[100:101], v4 offset:0
v_mfma_f32_16x16x32_bf16 v[164:167], v[36:39], v[20:23], 0
ds_read_b64_tr_b16 v[102:103], v4 offset:4096
v_mfma_f32_16x16x32_bf16 v[168:171], v[36:39], v[24:27], 0
ds_read_b128 v[88:91], v11 offset:4096
v_mfma_f32_16x16x32_bf16 v[172:175], v[36:39], v[28:31], 0
ds_read_b128 v[92:95], v11 offset:6144
v_mfma_f32_16x16x32_bf16 v[176:179], v[40:43], v[16:19], 0
ds_read_b64_tr_b16 v[104:105], v5 offset:0
v_mfma_f32_16x16x32_bf16 v[180:183], v[40:43], v[20:23], 0
ds_read_b64_tr_b16 v[106:107], v5 offset:4096
v_mfma_f32_16x16x32_bf16 v[184:187], v[40:43], v[24:27], 0
ds_read_b64_tr_b16 v[108:109], v6 offset:0
v_mfma_f32_16x16x32_bf16 v[188:191], v[40:43], v[28:31], 0
ds_read_b64_tr_b16 v[110:111], v6 offset:4096
v_mfma_f32_16x16x32_bf16 v[192:195], v[44:47], v[16:19], 0
ds_read_b64_tr_b16 v[128:129], v3 offset:8192
v_mfma_f32_16x16x32_bf16 v[196:199], v[44:47], v[20:23], 0
ds_read_b64_tr_b16 v[130:131], v3 offset:12288
v_mfma_f32_16x16x32_bf16 v[200:203], v[44:47], v[24:27], 0
ds_read_b128 v[112:115], v2 offset:1024
v_mfma_f32_16x16x32_bf16 v[204:207], v[44:47], v[28:31], 0
ds_read_b128 v[116:119], v2 offset:3072
v_mfma_f32_16x16x32_bf16 v[144:147], v[64:67], v[48:51], v[144:147]
ds_read_b64_tr_b16 v[132:133], v4 offset:8192
v_mfma_f32_16x16x32_bf16 v[148:151], v[64:67], v[52:55], v[148:151]
ds_read_b64_tr_b16 v[134:135], v4 offset:12288
v_mfma_f32_16x16x32_bf16 v[152:155], v[64:67], v[56:59], v[152:155]
ds_read_b128 v[120:123], v11 offset:5120
v_mfma_f32_16x16x32_bf16 v[156:159], v[64:67], v[60:63], v[156:159]
ds_read_b128 v[124:127], v11 offset:7168
v_mfma_f32_16x16x32_bf16 v[160:163], v[68:71], v[48:51], v[160:163]
ds_read_b64_tr_b16 v[136:137], v5 offset:8192
v_mfma_f32_16x16x32_bf16 v[164:167], v[68:71], v[52:55], v[164:167]
ds_read_b64_tr_b16 v[138:139], v5 offset:12288
v_mfma_f32_16x16x32_bf16 v[168:171], v[68:71], v[56:59], v[168:171]
ds_read_b64_tr_b16 v[140:141], v6 offset:8192
v_mfma_f32_16x16x32_bf16 v[172:175], v[68:71], v[60:63], v[172:175]
ds_read_b64_tr_b16 v[142:143], v6 offset:12288
v_mfma_f32_16x16x32_bf16 v[176:179], v[72:75], v[48:51], v[176:179]
s_add_u32 s60, s50, 32768
v_mfma_f32_16x16x32_bf16 v[180:183], v[72:75], v[52:55], v[180:183]
s_cmp_eq_u32 s60, 163840
v_mfma_f32_16x16x32_bf16 v[184:187], v[72:75], v[56:59], v[184:187]
s_cselect_b32 s60, 0, s60
v_mfma_f32_16x16x32_bf16 v[188:191], v[72:75], v[60:63], v[188:191]
s_sub_u32 s59, s60, s50
v_mfma_f32_16x16x32_bf16 v[192:195], v[76:79], v[48:51], v[192:195]
s_mov_b32 s50, s60
v_mfma_f32_16x16x32_bf16 v[196:199], v[76:79], v[52:55], v[196:199]
v_add_u32 v2, s59, v2
v_mfma_f32_16x16x32_bf16 v[200:203], v[76:79], v[56:59], v[200:203]
v_add_u32 v11, s59, v11
v_mfma_f32_16x16x32_bf16 v[204:207], v[76:79], v[60:63], v[204:207]
v_add_u32 v3, s59, v3
v_add_u32 v4, s59, v4
v_add_u32 v5, s59, v5
v_add_u32 v6, s59, v6
s_waitcnt lgkmcnt(0)
s_barrier
v_mfma_f32_16x16x32_bf16 v[144:147], v[96:99], v[80:83], v[144:147]
ds_read_b64_tr_b16 v[32:33], v3 offset:0
v_mfma_f32_16x16x32_bf16 v[148:151], v[96:99], v[84:87], v[148:151]
ds_read_b64_tr_b16 v[34:35], v3 offset:4096
v_mfma_f32_16x16x32_bf16 v[152:155], v[96:99], v[88:91], v[152:155]
ds_read_b128 v[16:19], v2 offset:0
v_mfma_f32_16x16x32_bf16 v[156:159], v[96:99], v[92:95], v[156:159]
ds_read_b128 v[20:23], v2 offset:2048
v_mfma_f32_16x16x32_bf16 v[160:163], v[100:103], v[80:83], v[160:163]
ds_read_b64_tr_b16 v[36:37], v4 offset:0
v_mfma_f32_16x16x32_bf16 v[164:167], v[100:103], v[84:87], v[164:167]
ds_read_b64_tr_b16 v[38:39], v4 offset:4096
v_mfma_f32_16x16x32_bf16 v[168:171], v[100:103], v[88:91], v[168:171]
ds_read_b128 v[24:27], v11 offset:4096
v_mfma_f32_16x16x32_bf16 v[172:175], v[100:103], v[92:95], v[172:175]
ds_read_b128 v[28:31], v11 offset:6144
v_mfma_f32_16x16x32_bf16 v[176:179], v[104:107], v[80:83], v[176:179]
ds_read_b64_tr_b16 v[40:41], v5 offset:0
v_mfma_f32_16x16x32_bf16 v[180:183], v[104:107], v[84:87], v[180:183]
ds_read_b64_tr_b16 v[42:43], v5 offset:4096
v_mfma_f32_16x16x32_bf16 v[184:187], v[104:107], v[88:91], v[184:187]
ds_read_b64_tr_b16 v[44:45], v6 offset:0
v_mfma_f32_16x16x32_bf16 v[188:191], v[104:107], v[92:95], v[188:191]
ds_read_b64_tr_b16 v[46:47], v6 offset:4096
v_mfma_f32_16x16x32_bf16 v[192:195], v[108:111], v[80:83], v[192:195]
ds_read_b64_tr_b16 v[64:65], v3 offset:8192
v_mfma_f32_16x16x32_bf16 v[196:199], v[108:111], v[84:87], v[196:199]
ds_read_b64_tr_b16 v[66:67], v3 offset:12288
v_mfma_f32_16x16x32_bf16 v[200:203], v[108:111], v[88:91], v[200:203]
ds_read_b128 v[48:51], v2 offset:1024
v_mfma_f32_16x16x32_bf16 v[204:207], v[108:111], v[92:95], v[204:207]
ds_read_b128 v[52:55], v2 offset:3072
v_mfma_f32_16x16x32_bf16 v[144:147], v[128:131], v[112:115], v[144:147]
ds_read_b64_tr_b16 v[68:69], v4 offset:8192
v_mfma_f32_16x16x32_bf16 v[148:151], v[128:131], v[116:119], v[148:151]
ds_read_b64_tr_b16 v[70:71], v4 offset:12288
v_mfma_f32_16x16x32_bf16 v[152:155], v[128:131], v[120:123], v[152:155]
ds_read_b128 v[56:59], v11 offset:5120
v_mfma_f32_16x16x32_bf16 v[156:159], v[128:131], v[124:127], v[156:159]
ds_read_b128 v[60:63], v11 offset:7168
v_mfma_f32_16x16x32_bf16 v[160:163], v[132:135], v[112:115], v[160:163]
ds_read_b64_tr_b16 v[72:73], v5 offset:8192
v_mfma_f32_16x16x32_bf16 v[164:167], v[132:135], v[116:119], v[164:167]
ds_read_b64_tr_b16 v[74:75], v5 offset:12288
v_mfma_f32_16x16x32_bf16 v[168:171], v[132:135], v[120:123], v[168:171]
ds_read_b64_tr_b16 v[76:77], v6 offset:8192
v_mfma_f32_16x16x32_bf16 v[172:175], v[132:135], v[124:127], v[172:175]
ds_read_b64_tr_b16 v[78:79], v6 offset:12288
v_mfma_f32_16x16x32_bf16 v[176:179], v[136:139], v[112:115], v[176:179]
s_add_u32 s60, s50, 32768
v_mfma_f32_16x16x32_bf16 v[180:183], v[136:139], v[116:119], v[180:183]
s_cmp_eq_u32 s60, 163840
v_mfma_f32_16x16x32_bf16 v[184:187], v[136:139], v[120:123], v[184:187]
s_cselect_b32 s60, 0, s60
v_mfma_f32_16x16x32_bf16 v[188:191], v[136:139], v[124:127], v[188:191]
s_sub_u32 s59, s60, s50
v_mfma_f32_16x16x32_bf16 v[192:195], v[140:143], v[112:115], v[192:195]
s_mov_b32 s50, s60
v_mfma_f32_16x16x32_bf16 v[196:199], v[140:143], v[116:119], v[196:199]
v_add_u32 v2, s59, v2
v_mfma_f32_16x16x32_bf16 v[200:203], v[140:143], v[120:123], v[200:203]
v_add_u32 v11, s59, v11
v_mfma_f32_16x16x32_bf16 v[204:207], v[140:143], v[124:127], v[204:207]
v_add_u32 v3, s59, v3
v_add_u32 v4, s59, v4
v_add_u32 v5, s59, v5
v_add_u32 v6, s59, v6
s_mov_b32 s49, 12
G2_LOOP:
s_waitcnt lgkmcnt(0)
s_barrier
v_mfma_f32_16x16x32_bf16 v[144:147], v[32:35], v[16:19], v[144:147]
ds_read_b64_tr_b16 v[96:97], v3 offset:0
v_mfma_f32_16x16x32_bf16 v[148:151], v[32:35], v[20:23], v[148:151]
ds_read_b64_tr_b16 v[98:99], v3 offset:4096
v_mfma_f32_16x16x32_bf16 v[152:155], v[32:35], v[24:27], v[152:155]
ds_read_b128 v[80:83], v2 offset:0
v_mfma_f32_16x16x32_bf16 v[156:159], v[32:35], v[28:31], v[156:159]
ds_read_b128 v[84:87], v2 offset:2048
v_mfma_f32_16x16x32_bf16 v[160:163], v[36:39], v[16:19], v[160:163]
ds_read_b64_tr_b16 v[100:101], v4 offset:0
v_mfma_f32_16x16x32_bf16 v[164:167], v[36:39], v[20:23], v[164:167]
ds_read_b64_tr_b16 v[102:103], v4 offset:4096
v_mfma_f32_16x16x32_bf16 v[168:171], v[36:39], v[24:27], v[168:171]
ds_read_b128 v[88:91], v11 offset:4096
v_mfma_f32_16x16x32_bf16 v[172:175], v[36:39], v[28:31], v[172:175]
ds_read_b128 v[92:95], v11 offset:6144
v_mfma_f32_16x16x32_bf16 v[176:179], v[40:43], v[16:19], v[176:179]
ds_read_b64_tr_b16 v[104:105], v5 offset:0
v_mfma_f32_16x16x32_bf16 v[180:183], v[40:43], v[20:23], v[180:183]
ds_read_b64_tr_b16 v[106:107], v5 offset:4096
v_mfma_f32_16x16x32_bf16 v[184:187], v[40:43], v[24:27], v[184:187]
ds_read_b64_tr_b16 v[108:109], v6 offset:0
v_mfma_f32_16x16x32_bf16 v[188:191], v[40:43], v[28:31], v[188:191]
ds_read_b64_tr_b16 v[110:111], v6 offset:4096
v_mfma_f32_16x16x32_bf16 v[192:195], v[44:47], v[16:19], v[192:195]
ds_read_b64_tr_b16 v[128:129], v3 offset:8192
v_mfma_f32_16x16x32_bf16 v[196:199], v[44:47], v[20:23], v[196:199]
ds_read_b64_tr_b16 v[130:131], v3 offset:12288
v_mfma_f32_16x16x32_bf16 v[200:203], v[44:47], v[24:27], v[200:203]
ds_read_b128 v[112:115], v2 offset:1024
v_mfma_f32_16x16x32_bf16 v[204:207], v[44:47], v[28:31], v[204:207]
ds_read_b128 v[116:119], v2 offset:3072
v_mfma_f32_16x16x32_bf16 v[144:147], v[64:67], v[48:51], v[144:147]
ds_read_b64_tr_b16 v[132:133], v4 offset:8192
v_mfma_f32_16x16x32_bf16 v[148:151], v[64:67], v[52:55], v[148:151]
ds_read_b64_tr_b16 v[134:135], v4 offset:12288
v_mfma_f32_16x16x32_bf16 v[152:155], v[64:67], v[56:59], v[152:155]
ds_read_b128 v[120:123], v11 offset:5120
v_mfma_f32_16x16x32_bf16 v[156:159], v[64:67], v[60:63], v[156:159]
ds_read_b128 v[124:127], v11 offset:7168
v_mfma_f32_16x16x32_bf16 v[160:163], v[68:71], v[48:51], v[160:163]
ds_read_b64_tr_b16 v[136:137], v5 offset:8192
v_mfma_f32_16x16x32_bf16 v[164:167], v[68:71], v[52:55], v[164:167]
ds_read_b64_tr_b16 v[138:139], v5 offset:12288
v_mfma_f32_16x16x32_bf16 v[168:171], v[68:71], v[56:59], v[168:171]
ds_read_b64_tr_b16 v[140:141], v6 offset:8192
v_mfma_f32_16x16x32_bf16 v[172:175], v[68:71], v[60:63], v[172:175]
ds_read_b64_tr_b16 v[142:143], v6 offset:12288
v_mfma_f32_16x16x32_bf16 v[176:179], v[72:75], v[48:51], v[176:179]
s_add_u32 s60, s50, 32768
v_mfma_f32_16x16x32_bf16 v[180:183], v[72:75], v[52:55], v[180:183]
s_cmp_eq_u32 s60, 163840
v_mfma_f32_16x16x32_bf16 v[184:187], v[72:75], v[56:59], v[184:187]
s_cselect_b32 s60, 0, s60
v_mfma_f32_16x16x32_bf16 v[188:191], v[72:75], v[60:63], v[188:191]
s_sub_u32 s59, s60, s50
v_mfma_f32_16x16x32_bf16 v[192:195], v[76:79], v[48:51], v[192:195]
s_mov_b32 s50, s60
v_mfma_f32_16x16x32_bf16 v[196:199], v[76:79], v[52:55], v[196:199]
v_add_u32 v2, s59, v2
v_mfma_f32_16x16x32_bf16 v[200:203], v[76:79], v[56:59], v[200:203]
v_add_u32 v11, s59, v11
v_mfma_f32_16x16x32_bf16 v[204:207], v[76:79], v[60:63], v[204:207]
v_add_u32 v3, s59, v3
v_add_u32 v4, s59, v4
v_add_u32 v5, s59, v5
v_add_u32 v6, s59, v6
s_waitcnt lgkmcnt(0)
s_barrier
v_mfma_f32_16x16x32_bf16 v[144:147], v[96:99], v[80:83], v[144:147]
ds_read_b64_tr_b16 v[32:33], v3 offset:0
v_mfma_f32_16x16x32_bf16 v[148:151], v[96:99], v[84:87], v[148:151]
ds_read_b64_tr_b16 v[34:35], v3 offset:4096
v_mfma_f32_16x16x32_bf16 v[152:155], v[96:99], v[88:91], v[152:155]
ds_read_b128 v[16:19], v2 offset:0
v_mfma_f32_16x16x32_bf16 v[156:159], v[96:99], v[92:95], v[156:159]
ds_read_b128 v[20:23], v2 offset:2048
v_mfma_f32_16x16x32_bf16 v[160:163], v[100:103], v[80:83], v[160:163]
ds_read_b64_tr_b16 v[36:37], v4 offset:0
v_mfma_f32_16x16x32_bf16 v[164:167], v[100:103], v[84:87], v[164:167]
ds_read_b64_tr_b16 v[38:39], v4 offset:4096
v_mfma_f32_16x16x32_bf16 v[168:171], v[100:103], v[88:91], v[168:171]
ds_read_b128 v[24:27], v11 offset:4096
v_mfma_f32_16x16x32_bf16 v[172:175], v[100:103], v[92:95], v[172:175]
ds_read_b128 v[28:31], v11 offset:6144
v_mfma_f32_16x16x32_bf16 v[176:179], v[104:107], v[80:83], v[176:179]
ds_read_b64_tr_b16 v[40:41], v5 offset:0
v_mfma_f32_16x16x32_bf16 v[180:183], v[104:107], v[84:87], v[180:183]
ds_read_b64_tr_b16 v[42:43], v5 offset:4096
v_mfma_f32_16x16x32_bf16 v[184:187], v[104:107], v[88:91], v[184:187]
ds_read_b64_tr_b16 v[44:45], v6 offset:0
v_mfma_f32_16x16x32_bf16 v[188:191], v[104:107], v[92:95], v[188:191]
ds_read_b64_tr_b16 v[46:47], v6 offset:4096
v_mfma_f32_16x16x32_bf16 v[192:195], v[108:111], v[80:83], v[192:195]
ds_read_b64_tr_b16 v[64:65], v3 offset:8192
v_mfma_f32_16x16x32_bf16 v[196:199], v[108:111], v[84:87], v[196:199]
ds_read_b64_tr_b16 v[66:67], v3 offset:12288
v_mfma_f32_16x16x32_bf16 v[200:203], v[108:111], v[88:91], v[200:203]
ds_read_b128 v[48:51], v2 offset:1024
v_mfma_f32_16x16x32_bf16 v[204:207], v[108:111], v[92:95], v[204:207]
ds_read_b128 v[52:55], v2 offset:3072
v_mfma_f32_16x16x32_bf16 v[144:147], v[128:131], v[112:115], v[144:147]
ds_read_b64_tr_b16 v[68:69], v4 offset:8192
v_mfma_f32_16x16x32_bf16 v[148:151], v[128:131], v[116:119], v[148:151]
ds_read_b64_tr_b16 v[70:71], v4 offset:12288
v_mfma_f32_16x16x32_bf16 v[152:155], v[128:131], v[120:123], v[152:155]
ds_read_b128 v[56:59], v11 offset:5120
v_mfma_f32_16x16x32_bf16 v[156:159], v[128:131], v[124:127], v[156:159]
ds_read_b128 v[60:63], v11 offset:7168
v_mfma_f32_16x16x32_bf16 v[160:163], v[132:135], v[112:115], v[160:163]
ds_read_b64_tr_b16 v[72:73], v5 offset:8192
v_mfma_f32_16x16x32_bf16 v[164:167], v[132:135], v[116:119], v[164:167]
ds_read_b64_tr_b16 v[74:75], v5 offset:12288
v_mfma_f32_16x16x32_bf16 v[168:171], v[132:135], v[120:123], v[168:171]
ds_read_b64_tr_b16 v[76:77], v6 offset:8192
v_mfma_f32_16x16x32_bf16 v[172:175], v[132:135], v[124:127], v[172:175]
ds_read_b64_tr_b16 v[78:79], v6 offset:12288
v_mfma_f32_16x16x32_bf16 v[176:179], v[136:139], v[112:115], v[176:179]
s_add_u32 s60, s50, 32768
v_mfma_f32_16x16x32_bf16 v[180:183], v[136:139], v[116:119], v[180:183]
s_cmp_eq_u32 s60, 163840
v_mfma_f32_16x16x32_bf16 v[184:187], v[136:139], v[120:123], v[184:187]
s_cselect_b32 s60, 0, s60
v_mfma_f32_16x16x32_bf16 v[188:191], v[136:139], v[124:127], v[188:191]
s_sub_u32 s59, s60, s50
v_mfma_f32_16x16x32_bf16 v[192:195], v[140:143], v[112:115], v[192:195]
s_mov_b32 s50, s60
v_mfma_f32_16x16x32_bf16 v[196:199], v[140:143], v[116:119], v[196:199]
v_add_u32 v2, s59, v2
v_mfma_f32_16x16x32_bf16 v[200:203], v[140:143], v[120:123], v[200:203]
v_add_u32 v11, s59, v11
v_mfma_f32_16x16x32_bf16 v[204:207], v[140:143], v[124:127], v[204:207]
v_add_u32 v3, s59, v3
v_add_u32 v4, s59, v4
v_add_u32 v5, s59, v5
v_add_u32 v6, s59, v6
s_sub_u32 s49, s49, 1
s_cmp_lg_u32 s49, 0
s_cbranch_scc1 G2_LOOP
s_waitcnt lgkmcnt(0)
s_barrier
v_mfma_f32_16x16x32_bf16 v[144:147], v[32:35], v[16:19], v[144:147]
ds_read_b64_tr_b16 v[96:97], v3 offset:0
v_mfma_f32_16x16x32_bf16 v[148:151], v[32:35], v[20:23], v[148:151]
ds_read_b64_tr_b16 v[98:99], v3 offset:4096
v_mfma_f32_16x16x32_bf16 v[152:155], v[32:35], v[24:27], v[152:155]
ds_read_b128 v[80:83], v2 offset:0
v_mfma_f32_16x16x32_bf16 v[156:159], v[32:35], v[28:31], v[156:159]
ds_read_b128 v[84:87], v2 offset:2048
v_mfma_f32_16x16x32_bf16 v[160:163], v[36:39], v[16:19], v[160:163]
ds_read_b64_tr_b16 v[100:101], v4 offset:0
v_mfma_f32_16x16x32_bf16 v[164:167], v[36:39], v[20:23], v[164:167]
ds_read_b64_tr_b16 v[102:103], v4 offset:4096
v_mfma_f32_16x16x32_bf16 v[168:171], v[36:39], v[24:27], v[168:171]
ds_read_b128 v[88:91], v11 offset:4096
v_mfma_f32_16x16x32_bf16 v[172:175], v[36:39], v[28:31], v[172:175]
ds_read_b128 v[92:95], v11 offset:6144
v_mfma_f32_16x16x32_bf16 v[176:179], v[40:43], v[16:19], v[176:179]
ds_read_b64_tr_b16 v[104:105], v5 offset:0
v_mfma_f32_16x16x32_bf16 v[180:183], v[40:43], v[20:23], v[180:183]
ds_read_b64_tr_b16 v[106:107], v5 offset:4096
v_mfma_f32_16x16x32_bf16 v[184:187], v[40:43], v[24:27], v[184:187]
ds_read_b64_tr_b16 v[108:109], v6 offset:0
v_mfma_f32_16x16x32_bf16 v[188:191], v[40:43], v[28:31], v[188:191]
ds_read_b64_tr_b16 v[110:111], v6 offset:4096
v_mfma_f32_16x16x32_bf16 v[192:195], v[44:47], v[16:19], v[192:195]
ds_read_b64_tr_b16 v[128:129], v3 offset:8192
v_mfma_f32_16x16x32_bf16 v[196:199], v[44:47], v[20:23], v[196:199]
ds_read_b64_tr_b16 v[130:131], v3 offset:12288
v_mfma_f32_16x16x32_bf16 v[200:203], v[44:47], v[24:27], v[200:203]
ds_read_b128 v[112:115], v2 offset:1024
v_mfma_f32_16x16x32_bf16 v[204:207], v[44:47], v[28:31], v[204:207]
ds_read_b128 v[116:119], v2 offset:3072
v_mfma_f32_16x16x32_bf16 v[144:147], v[64:67], v[48:51], v[144:147]
ds_read_b64_tr_b16 v[132:133], v4 offset:8192
v_mfma_f32_16x16x32_bf16 v[148:151], v[64:67], v[52:55], v[148:151]
ds_read_b64_tr_b16 v[134:135], v4 offset:12288
v_mfma_f32_16x16x32_bf16 v[152:155], v[64:67], v[56:59], v[152:155]
ds_read_b128 v[120:123], v11 offset:5120
v_mfma_f32_16x16x32_bf16 v[156:159], v[64:67], v[60:63], v[156:159]
ds_read_b128 v[124:127], v11 offset:7168
v_mfma_f32_16x16x32_bf16 v[160:163], v[68:71], v[48:51], v[160:163]
ds_read_b64_tr_b16 v[136:137], v5 offset:8192
v_mfma_f32_16x16x32_bf16 v[164:167], v[68:71], v[52:55], v[164:167]
ds_read_b64_tr_b16 v[138:139], v5 offset:12288
v_mfma_f32_16x16x32_bf16 v[168:171], v[68:71], v[56:59], v[168:171]
ds_read_b64_tr_b16 v[140:141], v6 offset:8192
v_mfma_f32_16x16x32_bf16 v[172:175], v[68:71], v[60:63], v[172:175]
ds_read_b64_tr_b16 v[142:143], v6 offset:12288
v_mfma_f32_16x16x32_bf16 v[176:179], v[72:75], v[48:51], v[176:179]
s_add_u32 s60, s50, 32768
v_mfma_f32_16x16x32_bf16 v[180:183], v[72:75], v[52:55], v[180:183]
s_cmp_eq_u32 s60, 163840
v_mfma_f32_16x16x32_bf16 v[184:187], v[72:75], v[56:59], v[184:187]
s_cselect_b32 s60, 0, s60
v_mfma_f32_16x16x32_bf16 v[188:191], v[72:75], v[60:63], v[188:191]
s_sub_u32 s59, s60, s50
v_mfma_f32_16x16x32_bf16 v[192:195], v[76:79], v[48:51], v[192:195]
s_mov_b32 s50, s60
v_mfma_f32_16x16x32_bf16 v[196:199], v[76:79], v[52:55], v[196:199]
v_add_u32 v2, s59, v2
v_mfma_f32_16x16x32_bf16 v[200:203], v[76:79], v[56:59], v[200:203]
v_add_u32 v11, s59, v11
v_mfma_f32_16x16x32_bf16 v[204:207], v[76:79], v[60:63], v[204:207]
v_add_u32 v3, s59, v3
v_add_u32 v4, s59, v4
v_add_u32 v5, s59, v5
v_add_u32 v6, s59, v6
s_waitcnt lgkmcnt(0)
v_mfma_f32_16x16x32_bf16 v[144:147], v[96:99], v[80:83], v[144:147]
v_mfma_f32_16x16x32_bf16 v[148:151], v[96:99], v[84:87], v[148:151]
v_mfma_f32_16x16x32_bf16 v[152:155], v[96:99], v[88:91], v[152:155]
v_mfma_f32_16x16x32_bf16 v[156:159], v[96:99], v[92:95], v[156:159]
v_mfma_f32_16x16x32_bf16 v[160:163], v[100:103], v[80:83], v[160:163]
v_mfma_f32_16x16x32_bf16 v[164:167], v[100:103], v[84:87], v[164:167]
v_mfma_f32_16x16x32_bf16 v[168:171], v[100:103], v[88:91], v[168:171]
v_mfma_f32_16x16x32_bf16 v[172:175], v[100:103], v[92:95], v[172:175]
v_mfma_f32_16x16x32_bf16 v[176:179], v[104:107], v[80:83], v[176:179]
v_mfma_f32_16x16x32_bf16 v[180:183], v[104:107], v[84:87], v[180:183]
v_mfma_f32_16x16x32_bf16 v[184:187], v[104:107], v[88:91], v[184:187]
v_mfma_f32_16x16x32_bf16 v[188:191], v[104:107], v[92:95], v[188:191]
v_mfma_f32_16x16x32_bf16 v[192:195], v[108:111], v[80:83], v[192:195]
v_mfma_f32_16x16x32_bf16 v[196:199], v[108:111], v[84:87], v[196:199]
v_mfma_f32_16x16x32_bf16 v[200:203], v[108:111], v[88:91], v[200:203]
v_mfma_f32_16x16x32_bf16 v[204:207], v[108:111], v[92:95], v[204:207]
v_mfma_f32_16x16x32_bf16 v[144:147], v[128:131], v[112:115], v[144:147]
v_mfma_f32_16x16x32_bf16 v[148:151], v[128:131], v[116:119], v[148:151]
v_mfma_f32_16x16x32_bf16 v[152:155], v[128:131], v[120:123], v[152:155]
v_mfma_f32_16x16x32_bf16 v[156:159], v[128:131], v[124:127], v[156:159]
v_mfma_f32_16x16x32_bf16 v[160:163], v[132:135], v[112:115], v[160:163]
v_mfma_f32_16x16x32_bf16 v[164:167], v[132:135], v[116:119], v[164:167]
v_mfma_f32_16x16x32_bf16 v[168:171], v[132:135], v[120:123], v[168:171]
v_mfma_f32_16x16x32_bf16 v[172:175], v[132:135], v[124:127], v[172:175]
v_mfma_f32_16x16x32_bf16 v[176:179], v[136:139], v[112:115], v[176:179]
v_mfma_f32_16x16x32_bf16 v[180:183], v[136:139], v[116:119], v[180:183]
v_mfma_f32_16x16x32_bf16 v[184:187], v[136:139], v[120:123], v[184:187]
v_mfma_f32_16x16x32_bf16 v[188:191], v[136:139], v[124:127], v[188:191]
v_mfma_f32_16x16x32_bf16 v[192:195], v[140:143], v[112:115], v[192:195]
v_mfma_f32_16x16x32_bf16 v[196:199], v[140:143], v[116:119], v[196:199]
v_mfma_f32_16x16x32_bf16 v[200:203], v[140:143], v[120:123], v[200:203]
v_mfma_f32_16x16x32_bf16 v[204:207], v[140:143], v[124:127], v[204:207]
s_waitcnt vmcnt(0)
v_lshrrev_b32 v8, 4, v1
v_lshlrev_b32 v8, 14, v8
v_and_b32 v9, 15, v1
v_lshl_add_u32 v8, v9, 4, v8
v_cvt_pk_bf16_f32 v16, v152, v153
v_cvt_pk_bf16_f32 v17, v154, v155
v_cvt_pk_bf16_f32 v18, v156, v157
v_cvt_pk_bf16_f32 v19, v158, v159
s_add_u32 s67, s41, 0
buffer_store_dwordx4 v[16:19], v8, s[24:27], s67 offen sc1
v_cvt_pk_bf16_f32 v20, v168, v169
v_cvt_pk_bf16_f32 v21, v170, v171
v_cvt_pk_bf16_f32 v22, v172, v173
v_cvt_pk_bf16_f32 v23, v174, v175
s_add_u32 s67, s41, 65536
buffer_store_dwordx4 v[20:23], v8, s[24:27], s67 offen sc1
v_cvt_pk_bf16_f32 v24, v184, v185
v_cvt_pk_bf16_f32 v25, v186, v187
v_cvt_pk_bf16_f32 v26, v188, v189
v_cvt_pk_bf16_f32 v27, v190, v191
s_add_u32 s67, s41, 131072
buffer_store_dwordx4 v[24:27], v8, s[24:27], s67 offen sc1
v_cvt_pk_bf16_f32 v28, v200, v201
v_cvt_pk_bf16_f32 v29, v202, v203
v_cvt_pk_bf16_f32 v30, v204, v205
v_cvt_pk_bf16_f32 v31, v206, v207
s_add_u32 s67, s41, 196608
buffer_store_dwordx4 v[28:31], v8, s[24:27], s67 offen sc1
s_lshl_b32 s64, s45, 3
s_add_u32 s64, s64, s46
s_lshl_b32 s64, s64, 1
s_add_u32 s65, s64, s43
s_xor_b32 s66, s43, 1
s_add_u32 s66, s64, s66
s_lshl_b32 s65, s65, 2
s_add_u32 s65, s65, s44
s_lshl_b32 s65, s65, 7
s_lshl_b32 s66, s66, 2
s_add_u32 s66, s66, s44
s_lshl_b32 s66, s66, 7
s_mov_b32 s61, 0xffff0000
v_lshlrev_b32 v128, 16, v224
v_and_b32 v129, s61, v224
v_lshlrev_b32 v130, 16, v225
v_and_b32 v131, s61, v225
v_lshlrev_b32 v132, 16, v226
v_and_b32 v133, s61, v226
v_lshlrev_b32 v134, 16, v227
v_and_b32 v135, s61, v227
v_lshlrev_b32 v136, 16, v228
v_and_b32 v137, s61, v228
v_lshlrev_b32 v138, 16, v229
v_and_b32 v139, s61, v229
v_lshlrev_b32 v140, 16, v230
v_and_b32 v141, s61, v230
v_lshlrev_b32 v142, 16, v231
v_and_b32 v143, s61, v231
v_lshlrev_b32 v56, 16, v208
v_and_b32 v57, s61, v208
v_lshlrev_b32 v58, 16, v209
v_and_b32 v59, s61, v209
v_pk_add_f32 v[144:145], v[144:145], v[128:129]
v_pk_add_f32 v[144:145], v[144:145], v[56:57]
v_pk_add_f32 v[146:147], v[146:147], v[130:131]
v_pk_add_f32 v[146:147], v[146:147], v[58:59]
v_lshlrev_b32 v60, 16, v210
v_and_b32 v61, s61, v210
v_lshlrev_b32 v62, 16, v211
v_and_b32 v63, s61, v211
v_pk_add_f32 v[148:149], v[148:149], v[128:129]
v_pk_add_f32 v[148:149], v[148:149], v[60:61]
v_pk_add_f32 v[150:151], v[150:151], v[130:131]
v_pk_add_f32 v[150:151], v[150:151], v[62:63]
v_lshlrev_b32 v56, 16, v212
v_and_b32 v57, s61, v212
v_lshlrev_b32 v58, 16, v213
v_and_b32 v59, s61, v213
v_pk_add_f32 v[160:161], v[160:161], v[132:133]
v_pk_add_f32 v[160:161], v[160:161], v[56:57]
v_pk_add_f32 v[162:163], v[162:163], v[134:135]
v_pk_add_f32 v[162:163], v[162:163], v[58:59]
v_lshlrev_b32 v60, 16, v214
v_and_b32 v61, s61, v214
v_lshlrev_b32 v62, 16, v215
v_and_b32 v63, s61, v215
v_pk_add_f32 v[164:165], v[164:165], v[132:133]
v_pk_add_f32 v[164:165], v[164:165], v[60:61]
v_pk_add_f32 v[166:167], v[166:167], v[134:135]
v_pk_add_f32 v[166:167], v[166:167], v[62:63]
v_lshlrev_b32 v56, 16, v216
v_and_b32 v57, s61, v216
v_lshlrev_b32 v58, 16, v217
v_and_b32 v59, s61, v217
v_pk_add_f32 v[176:177], v[176:177], v[136:137]
v_pk_add_f32 v[176:177], v[176:177], v[56:57]
v_pk_add_f32 v[178:179], v[178:179], v[138:139]
v_pk_add_f32 v[178:179], v[178:179], v[58:59]
v_lshlrev_b32 v60, 16, v218
v_and_b32 v61, s61, v218
v_lshlrev_b32 v62, 16, v219
v_and_b32 v63, s61, v219
v_pk_add_f32 v[180:181], v[180:181], v[136:137]
v_pk_add_f32 v[180:181], v[180:181], v[60:61]
v_pk_add_f32 v[182:183], v[182:183], v[138:139]
v_pk_add_f32 v[182:183], v[182:183], v[62:63]
v_lshlrev_b32 v56, 16, v220
v_and_b32 v57, s61, v220
v_lshlrev_b32 v58, 16, v221
v_and_b32 v59, s61, v221
v_pk_add_f32 v[192:193], v[192:193], v[140:141]
v_pk_add_f32 v[192:193], v[192:193], v[56:57]
v_pk_add_f32 v[194:195], v[194:195], v[142:143]
v_pk_add_f32 v[194:195], v[194:195], v[58:59]
v_lshlrev_b32 v60, 16, v222
v_and_b32 v61, s61, v222
v_lshlrev_b32 v62, 16, v223
v_and_b32 v63, s61, v223
v_pk_add_f32 v[196:197], v[196:197], v[140:141]
v_pk_add_f32 v[196:197], v[196:197], v[60:61]
v_pk_add_f32 v[198:199], v[198:199], v[142:143]
v_pk_add_f32 v[198:199], v[198:199], v[62:63]
v_lshrrev_b32 v12, 4, v1
v_and_b32 v13, 15, v1
v_and_b32 v7, 1, v12
v_lshlrev_b32 v7, 5, v7
v_lshrrev_b32 v9, 1, v12
v_lshl_add_u32 v7, v9, 4, v7
v_lshl_add_u32 v7, v13, 11, v7
s_lshl_b32 s64, s71, 11
s_lshl_b32 s67, s46, 8
s_add_u32 s64, s64, s67
s_lshl_b32 s67, s48, 7
s_add_u32 s64, s64, s67
v_mov_b32 v9, 0x5eed1234
v_mov_b32 v10, 0
s_waitcnt vmcnt(0)
s_mov_b64 s[62:63], exec
s_mov_b64 exec, 1
buffer_store_dword v9, v10, s[52:55], s65 offen sc1
s_mov_b64 exec, s[62:63]
s_mov_b32 s69, 200000
G2_POLL:
buffer_load_dword v9, v10, s[52:55], s66 offen sc1
s_waitcnt vmcnt(0)
v_readfirstlane_b32 s62, v9
s_nop 3
s_cmp_eq_u32 s62, 0x5eed1234
s_cbranch_scc1 G2_GOT
s_sub_u32 s69, s69, 1
s_cmp_lg_u32 s69, 0
s_cbranch_scc1 G2_POLL
G2_GOT:
s_add_u32 s67, s40, 0
buffer_load_dwordx4 v[64:67], v8, s[24:27], s67 offen sc1
s_add_u32 s67, s40, 65536
buffer_load_dwordx4 v[68:71], v8, s[24:27], s67 offen sc1
s_add_u32 s67, s40, 131072
buffer_load_dwordx4 v[72:75], v8, s[24:27], s67 offen sc1
s_add_u32 s67, s40, 196608
buffer_load_dwordx4 v[76:79], v8, s[24:27], s67 offen sc1
s_waitcnt vmcnt(2)
v_lshlrev_b32 v60, 16, v64
v_and_b32 v61, s61, v64
v_lshlrev_b32 v62, 16, v65
v_and_b32 v63, s61, v65
v_pk_add_f32 v[144:145], v[144:145], v[60:61]
v_pk_add_f32 v[146:147], v[146:147], v[62:63]
v_cvt_pk_bf16_f32 v16, v144, v145
v_cvt_pk_bf16_f32 v17, v146, v147
v_lshlrev_b32 v60, 16, v68
v_and_b32 v61, s61, v68
v_lshlrev_b32 v62, 16, v69
v_and_b32 v63, s61, v69
v_pk_add_f32 v[160:161], v[160:161], v[60:61]
v_pk_add_f32 v[162:163], v[162:163], v[62:63]
v_cvt_pk_bf16_f32 v18, v160, v161
v_cvt_pk_bf16_f32 v19, v162, v163
s_nop 0
v_permlane16_swap_b32 v16, v18
v_permlane16_swap_b32 v17, v19
s_add_u32 s65, s64, 0
buffer_store_dwordx4 v[16:19], v7, s[32:35], s65 offen sc1
v_lshlrev_b32 v60, 16, v66
v_and_b32 v61, s61, v66
v_lshlrev_b32 v62, 16, v67
v_and_b32 v63, s61, v67
v_pk_add_f32 v[148:149], v[148:149], v[60:61]
v_pk_add_f32 v[150:151], v[150:151], v[62:63]
v_cvt_pk_bf16_f32 v20, v148, v149
v_cvt_pk_bf16_f32 v21, v150, v151
v_lshlrev_b32 v60, 16, v70
v_and_b32 v61, s61, v70
v_lshlrev_b32 v62, 16, v71
v_and_b32 v63, s61, v71
v_pk_add_f32 v[164:165], v[164:165], v[60:61]
v_pk_add_f32 v[166:167], v[166:167], v[62:63]
v_cvt_pk_bf16_f32 v22, v164, v165
v_cvt_pk_bf16_f32 v23, v166, v167
s_nop 0
v_permlane16_swap_b32 v20, v22
v_permlane16_swap_b32 v21, v23
s_add_u32 s65, s64, 32768
buffer_store_dwordx4 v[20:23], v7, s[32:35], s65 offen sc1
s_waitcnt vmcnt(2)
v_lshlrev_b32 v60, 16, v72
v_and_b32 v61, s61, v72
v_lshlrev_b32 v62, 16, v73
v_and_b32 v63, s61, v73
v_pk_add_f32 v[176:177], v[176:177], v[60:61]
v_pk_add_f32 v[178:179], v[178:179], v[62:63]
v_cvt_pk_bf16_f32 v16, v176, v177
v_cvt_pk_bf16_f32 v17, v178, v179
v_lshlrev_b32 v60, 16, v76
v_and_b32 v61, s61, v76
v_lshlrev_b32 v62, 16, v77
v_and_b32 v63, s61, v77
v_pk_add_f32 v[192:193], v[192:193], v[60:61]
v_pk_add_f32 v[194:195], v[194:195], v[62:63]
v_cvt_pk_bf16_f32 v18, v192, v193
v_cvt_pk_bf16_f32 v19, v194, v195
s_nop 0
v_permlane16_swap_b32 v16, v18
v_permlane16_swap_b32 v17, v19
s_add_u32 s65, s64, 64
buffer_store_dwordx4 v[16:19], v7, s[32:35], s65 offen sc1
v_lshlrev_b32 v60, 16, v74
v_and_b32 v61, s61, v74
v_lshlrev_b32 v62, 16, v75
v_and_b32 v63, s61, v75
v_pk_add_f32 v[180:181], v[180:181], v[60:61]
v_pk_add_f32 v[182:183], v[182:183], v[62:63]
v_cvt_pk_bf16_f32 v20, v180, v181
v_cvt_pk_bf16_f32 v21, v182, v183
v_lshlrev_b32 v60, 16, v78
v_and_b32 v61, s61, v78
v_lshlrev_b32 v62, 16, v79
v_and_b32 v63, s61, v79
v_pk_add_f32 v[196:197], v[196:197], v[60:61]
v_pk_add_f32 v[198:199], v[198:199], v[62:63]
v_cvt_pk_bf16_f32 v22, v196, v197
v_cvt_pk_bf16_f32 v23, v198, v199
s_nop 0
v_permlane16_swap_b32 v20, v22
v_permlane16_swap_b32 v21, v23
s_add_u32 s65, s64, 32832
buffer_store_dwordx4 v[20:23], v7, s[32:35], s65 offen sc1
s_branch P3_DONE
G2_DMA:
s_setprio 2
s_sub_u32 s50, s44, 4
v_lshlrev_b32 v2, 4, v1
v_lshrrev_b32 v16, 4, v1
v_and_b32 v17, 15, v1
v_add_u32 v18, 0, v16
v_lshlrev_b32 v18, 1, v18
v_xor_b32 v18, v17, v18
v_lshlrev_b32 v18, 4, v18
v_lshl_add_u32 v3, v16, 11, v18
v_add_u32 v18, 4, v16
v_lshlrev_b32 v18, 1, v18
v_xor_b32 v18, v17, v18
v_lshlrev_b32 v18, 4, v18
v_lshl_add_u32 v4, v16, 11, v18
s_lshl_b32 s51, s45, 3
s_lshl_b32 s64, s50, 1
s_add_u32 s51, s51, s64
s_mul_i32 s51, s51, 112
s_mul_i32 s64, s43, 56
s_add_u32 s51, s51, s64
s_lshl_b32 s51, s51, 10
s_mul_i32 s52, s43, 3670016
s_lshl_b32 s64, s50, 15
s_add_u32 s52, s52, s64
s_lshl_b32 s64, s46, 8
s_add_u32 s52, s52, s64
s_lshl_b32 s56, s50, 12
s_lshl_b32 s57, s50, 12
s_add_u32 s57, s57, 16384
s_mov_b32 s16, s12
s_mov_b32 s17, s13
s_mov_b32 s18, 0xe00000
s_mov_b32 s19, 0x20000
s_mov_b32 s20, s8
s_mov_b32 s21, s9
s_mov_b32 s22, 0x700000
s_mov_b32 s23, 0x20000
s_mov_b32 s55, 0
s_add_u32 s53, s55, s56
s_add_u32 s58, s55, s57
s_add_u32 m0, s53, 0
s_add_u32 s54, s51, 0
buffer_load_dwordx4 v2, s[16:19], s54 offen lds
s_add_u32 m0, s53, 1024
s_add_u32 s54, s51, 1024
buffer_load_dwordx4 v2, s[16:19], s54 offen lds
s_add_u32 m0, s53, 2048
s_add_u32 s54, s51, 114688
buffer_load_dwordx4 v2, s[16:19], s54 offen lds
s_add_u32 m0, s53, 3072
s_add_u32 s54, s51, 115712
buffer_load_dwordx4 v2, s[16:19], s54 offen lds
s_add_u32 s51, s51, 2048
s_add_u32 s52, s52, 131072
s_add_u32 s55, s55, 32768
s_cmp_eq_u32 s55, 163840
s_cselect_b32 s55, 0, s55
s_add_u32 s53, s55, s56
s_add_u32 s58, s55, s57
s_add_u32 m0, s53, 0
s_add_u32 s54, s51, 0
buffer_load_dwordx4 v2, s[16:19], s54 offen lds
s_add_u32 m0, s53, 1024
s_add_u32 s54, s51, 1024
buffer_load_dwordx4 v2, s[16:19], s54 offen lds
s_add_u32 m0, s53, 2048
s_add_u32 s54, s51, 114688
buffer_load_dwordx4 v2, s[16:19], s54 offen lds
s_add_u32 m0, s53, 3072
s_add_u32 s54, s51, 115712
buffer_load_dwordx4 v2, s[16:19], s54 offen lds
s_add_u32 s51, s51, 2048
s_add_u32 s52, s52, 131072
s_add_u32 s55, s55, 32768
s_cmp_eq_u32 s55, 163840
s_cselect_b32 s55, 0, s55
s_add_u32 s53, s55, s56
s_add_u32 s58, s55, s57
s_add_u32 m0, s53, 0
s_add_u32 s54, s51, 0
buffer_load_dwordx4 v2, s[16:19], s54 offen lds
s_add_u32 m0, s53, 1024
s_add_u32 s54, s51, 1024
buffer_load_dwordx4 v2, s[16:19], s54 offen lds
s_add_u32 m0, s53, 2048
s_add_u32 s54, s51, 114688
buffer_load_dwordx4 v2, s[16:19], s54 offen lds
s_add_u32 m0, s53, 3072
s_add_u32 s54, s51, 115712
buffer_load_dwordx4 v2, s[16:19], s54 offen lds
s_add_u32 s51, s51, 2048
s_add_u32 s52, s52, 131072
s_add_u32 s55, s55, 32768
s_cmp_eq_u32 s55, 163840
s_cselect_b32 s55, 0, s55
s_add_u32 s53, s55, s56
s_add_u32 s58, s55, s57
s_add_u32 m0, s53, 0
s_add_u32 s54, s51, 0
buffer_load_dwordx4 v2, s[16:19], s54 offen lds
s_add_u32 m0, s53, 1024
s_add_u32 s54, s51, 1024
buffer_load_dwordx4 v2, s[16:19], s54 offen lds
s_add_u32 m0, s53, 2048
s_add_u32 s54, s51, 114688
buffer_load_dwordx4 v2, s[16:19], s54 offen lds
s_add_u32 m0, s53, 3072
s_add_u32 s54, s51, 115712
buffer_load_dwordx4 v2, s[16:19], s54 offen lds
s_add_u32 s51, s51, 2048
s_add_u32 s52, s52, 131072
s_add_u32 s55, s55, 32768
s_cmp_eq_u32 s55, 163840
s_cselect_b32 s55, 0, s55
s_add_u32 s53, s55, s56
s_add_u32 s58, s55, s57
s_add_u32 m0, s53, 0
s_add_u32 s54, s51, 0
buffer_load_dwordx4 v2, s[16:19], s54 offen lds
s_add_u32 m0, s53, 1024
s_add_u32 s54, s51, 1024
buffer_load_dwordx4 v2, s[16:19], s54 offen lds
s_add_u32 m0, s53, 2048
s_add_u32 s54, s51, 114688
buffer_load_dwordx4 v2, s[16:19], s54 offen lds
s_add_u32 m0, s53, 3072
s_add_u32 s54, s51, 115712
buffer_load_dwordx4 v2, s[16:19], s54 offen lds
s_add_u32 s51, s51, 2048
s_add_u32 s52, s52, 131072
s_add_u32 s55, s55, 32768
s_cmp_eq_u32 s55, 163840
s_cselect_b32 s55, 0, s55
s_waitcnt vmcnt(16)
s_barrier
s_waitcnt vmcnt(12)
s_barrier
s_add_u32 s53, s55, s56
s_add_u32 s58, s55, s57
s_add_u32 m0, s53, 0
s_add_u32 s54, s51, 0
buffer_load_dwordx4 v2, s[16:19], s54 offen lds
s_add_u32 m0, s53, 1024
s_add_u32 s54, s51, 1024
buffer_load_dwordx4 v2, s[16:19], s54 offen lds
s_add_u32 m0, s53, 2048
s_add_u32 s54, s51, 114688
buffer_load_dwordx4 v2, s[16:19], s54 offen lds
s_add_u32 m0, s53, 3072
s_add_u32 s54, s51, 115712
buffer_load_dwordx4 v2, s[16:19], s54 offen lds
s_add_u32 m0, s58, 0
s_add_u32 s54, s52, 0
buffer_load_dwordx4 v3, s[20:23], s54 offen lds
s_add_u32 m0, s58, 1024
s_add_u32 s54, s52, 8192
buffer_load_dwordx4 v4, s[20:23], s54 offen lds
s_add_u32 m0, s58, 2048
s_add_u32 s54, s52, 16384
buffer_load_dwordx4 v3, s[20:23], s54 offen lds
s_add_u32 m0, s58, 3072
s_add_u32 s54, s52, 24576
buffer_load_dwordx4 v4, s[20:23], s54 offen lds
s_add_u32 s51, s51, 2048
s_add_u32 s52, s52, 131072
s_add_u32 s55, s55, 32768
s_cmp_eq_u32 s55, 163840
s_cselect_b32 s55, 0, s55
s_load_dword s96, s[66:67], 0
s_load_dword s97, s[66:67], 64
s_load_dword s98, s[68:69], 0
s_load_dword s99, s[68:69], 64
s_add_u32 s66, s66, 131072
s_addc_u32 s67, s67, 0
s_add_u32 s68, s68, 131072
s_addc_u32 s69, s69, 0
s_waitcnt vmcnt(16)
s_barrier
s_add_u32 s53, s55, s56
s_add_u32 s58, s55, s57
s_add_u32 m0, s53, 0
s_add_u32 s54, s51, 0
buffer_load_dwordx4 v2, s[16:19], s54 offen lds
s_add_u32 m0, s53, 1024
s_add_u32 s54, s51, 1024
buffer_load_dwordx4 v2, s[16:19], s54 offen lds
s_add_u32 m0, s53, 2048
s_add_u32 s54, s51, 114688
buffer_load_dwordx4 v2, s[16:19], s54 offen lds
s_add_u32 m0, s53, 3072
s_add_u32 s54, s51, 115712
buffer_load_dwordx4 v2, s[16:19], s54 offen lds
s_add_u32 m0, s58, 0
s_add_u32 s54, s52, 0
buffer_load_dwordx4 v3, s[20:23], s54 offen lds
s_add_u32 m0, s58, 1024
s_add_u32 s54, s52, 8192
buffer_load_dwordx4 v4, s[20:23], s54 offen lds
s_add_u32 m0, s58, 2048
s_add_u32 s54, s52, 16384
buffer_load_dwordx4 v3, s[20:23], s54 offen lds
s_add_u32 m0, s58, 3072
s_add_u32 s54, s52, 24576
buffer_load_dwordx4 v4, s[20:23], s54 offen lds
s_add_u32 s51, s51, 2048
s_add_u32 s52, s52, 131072
s_add_u32 s55, s55, 32768
s_cmp_eq_u32 s55, 163840
s_cselect_b32 s55, 0, s55
s_load_dword s96, s[66:67], 0
s_load_dword s97, s[66:67], 64
s_load_dword s98, s[68:69], 0
s_load_dword s99, s[68:69], 64
s_add_u32 s66, s66, 131072
s_addc_u32 s67, s67, 0
s_add_u32 s68, s68, 131072
s_addc_u32 s69, s69, 0
s_waitcnt vmcnt(20)
s_barrier
s_add_u32 s53, s55, s56
s_add_u32 s58, s55, s57
s_add_u32 m0, s53, 0
s_add_u32 s54, s51, 0
buffer_load_dwordx4 v2, s[16:19], s54 offen lds
s_add_u32 m0, s53, 1024
s_add_u32 s54, s51, 1024
buffer_load_dwordx4 v2, s[16:19], s54 offen lds
s_add_u32 m0, s53, 2048
s_add_u32 s54, s51, 114688
buffer_load_dwordx4 v2, s[16:19], s54 offen lds
s_add_u32 m0, s53, 3072
s_add_u32 s54, s51, 115712
buffer_load_dwordx4 v2, s[16:19], s54 offen lds
s_add_u32 m0, s58, 0
s_add_u32 s54, s52, 0
buffer_load_dwordx4 v3, s[20:23], s54 offen lds
s_add_u32 m0, s58, 1024
s_add_u32 s54, s52, 8192
buffer_load_dwordx4 v4, s[20:23], s54 offen lds
s_add_u32 m0, s58, 2048
s_add_u32 s54, s52, 16384
buffer_load_dwordx4 v3, s[20:23], s54 offen lds
s_add_u32 m0, s58, 3072
s_add_u32 s54, s52, 24576
buffer_load_dwordx4 v4, s[20:23], s54 offen lds
s_add_u32 s51, s51, 2048
s_add_u32 s52, s52, 131072
s_add_u32 s55, s55, 32768
s_cmp_eq_u32 s55, 163840
s_cselect_b32 s55, 0, s55
s_load_dword s96, s[66:67], 0
s_load_dword s97, s[66:67], 64
s_load_dword s98, s[68:69], 0
s_load_dword s99, s[68:69], 64
s_add_u32 s66, s66, 131072
s_addc_u32 s67, s67, 0
s_add_u32 s68, s68, 131072
s_addc_u32 s69, s69, 0
s_mov_b32 s49, 20
s_mov_b32 s42, 15
G2D_LOOP:
s_waitcnt vmcnt(24)
s_barrier
s_add_u32 s53, s55, s56
s_add_u32 s58, s55, s57
s_add_u32 m0, s53, 0
s_add_u32 s54, s51, 0
buffer_load_dwordx4 v2, s[16:19], s54 offen lds
s_add_u32 m0, s53, 1024
s_add_u32 s54, s51, 1024
buffer_load_dwordx4 v2, s[16:19], s54 offen lds
s_add_u32 m0, s53, 2048
s_add_u32 s54, s51, 114688
buffer_load_dwordx4 v2, s[16:19], s54 offen lds
s_add_u32 m0, s53, 3072
s_add_u32 s54, s51, 115712
buffer_load_dwordx4 v2, s[16:19], s54 offen lds
s_add_u32 m0, s58, 0
s_add_u32 s54, s52, 0
buffer_load_dwordx4 v3, s[20:23], s54 offen lds
s_add_u32 m0, s58, 1024
s_add_u32 s54, s52, 8192
buffer_load_dwordx4 v4, s[20:23], s54 offen lds
s_add_u32 m0, s58, 2048
s_add_u32 s54, s52, 16384
buffer_load_dwordx4 v3, s[20:23], s54 offen lds
s_add_u32 m0, s58, 3072
s_add_u32 s54, s52, 24576
buffer_load_dwordx4 v4, s[20:23], s54 offen lds
s_add_u32 s51, s51, 2048
s_add_u32 s52, s52, 131072
s_add_u32 s55, s55, 32768
s_cmp_eq_u32 s55, 163840
s_cselect_b32 s55, 0, s55
s_cmp_eq_u32 s42, 0
s_cbranch_scc1 G2D_NOJIT
s_load_dword s96, s[66:67], 0
s_load_dword s97, s[66:67], 64
s_load_dword s98, s[68:69], 0
s_load_dword s99, s[68:69], 64
s_add_u32 s66, s66, 131072
s_addc_u32 s67, s67, 0
s_add_u32 s68, s68, 131072
s_addc_u32 s69, s69, 0
s_sub_u32 s42, s42, 1
G2D_NOJIT:
s_sub_u32 s49, s49, 1
s_cmp_lg_u32 s49, 0
s_cbranch_scc1 G2D_LOOP
s_waitcnt vmcnt(24)
s_barrier
s_waitcnt vmcnt(16)
s_barrier
s_waitcnt vmcnt(8)
s_barrier
s_waitcnt vmcnt(0)
s_barrier
s_branch P3_DONE
CODE_G2_E:
P3_DONE:
GZ_END:
s_endpgm

.section .rodata,"a"
.p2align 6
.amdhsa_kernel sequential_preLN__ssm_conv_h3__mixer_channel_mlp__prompt_kernel
  .amdhsa_next_free_vgpr 140
  .amdhsa_next_free_sgpr 102
  .amdhsa_accum_offset 140
  .amdhsa_group_segment_fixed_size 0
  .amdhsa_kernarg_size 112
  .amdhsa_user_sgpr_count 2
  .amdhsa_user_sgpr_kernarg_segment_ptr 1
  .amdhsa_system_sgpr_workgroup_id_x 1
  .amdhsa_float_denorm_mode_32 3
.end_amdhsa_kernel

.section .rodata,"a"
.p2align 6
.amdhsa_kernel k1_kernel
  .amdhsa_next_free_vgpr 212
  .amdhsa_next_free_sgpr 102
  .amdhsa_accum_offset 212
  .amdhsa_group_segment_fixed_size 0
  .amdhsa_kernarg_size 112
  .amdhsa_user_sgpr_count 2
  .amdhsa_user_sgpr_kernarg_segment_ptr 1
  .amdhsa_system_sgpr_workgroup_id_x 1
  .amdhsa_float_denorm_mode_32 3
.end_amdhsa_kernel

.section .rodata,"a"
.p2align 6
.amdhsa_kernel gz_kernel
  .amdhsa_next_free_vgpr 248
  .amdhsa_next_free_sgpr 102
  .amdhsa_accum_offset 248
  .amdhsa_group_segment_fixed_size 0
  .amdhsa_kernarg_size 112
  .amdhsa_user_sgpr_count 2
  .amdhsa_user_sgpr_kernarg_segment_ptr 1
  .amdhsa_system_sgpr_workgroup_id_x 1
  .amdhsa_float_denorm_mode_32 3
.end_amdhsa_kernel
```
